```python
import torch

def _softmax(x, axis=-1):
    return torch.softmax(x, dim=axis)
def _gelu(x):
    return torch.nn.functional.gelu(x, approximate="tanh")
def _silu(x):
    return torch.nn.functional.silu(x)
def _sigmoid(x):
    return torch.sigmoid(x)
def _layernorm(x, axis=-1, eps=1e-5):
    m = x.mean(dim=axis, keepdim=True)
    v = x.var(dim=axis, keepdim=True, unbiased=False)
    return (x - m) / torch.sqrt(v + eps)
def _scatter_add(tgt, idx, src, axis=0):
    return tgt.clone().index_add_(axis, idx, src)
def _segment_sum(src, seg, n):
    out = torch.zeros((n,) + src.shape[1:], dtype=src.dtype)
    return out.index_add_(0, seg, src)
def _pad(x, pw):
    flat = tuple(v for pair in reversed(pw) for v in pair)
    return torch.nn.functional.pad(x, flat)

kernel_name = 'gated_mix__sliding_block_cached__dense_activation_relu__decode'

def setup_inputs():

    _w = (lambda a: (lambda t: t.to(torch.bfloat16) if t.is_floating_point() else t)(torch.as_tensor(a)))
    def _A_setup():
        B, Sq, D = 4, 1, 576
        Hq, Hkv, Sk, Dh = 32, 16, 4096, 128
        assert Hq % Hkv == 0, (Hq, Hkv)
        return {
            "x": _w((lambda *s: torch.randn(*s, dtype=torch.bfloat16) * 0.05)(B, Sq, D)),
            "k_cache": _w((lambda *s: torch.randn(*s, dtype=torch.bfloat16) * 6.4)(B, Hkv, Sk, Dh)),
            "v_cache": _w((lambda *s: torch.randn(*s, dtype=torch.bfloat16) * 0.4)(B, Hkv, Sk, Dh)),
            "wq": _w((lambda *s: torch.randn(*s, dtype=torch.bfloat16) * 6.4)(D, Hq * Dh) * (D ** -0.5)),
            "wo": _w((lambda *s: torch.randn(*s, dtype=torch.bfloat16) * 0.4)(Hq * Dh, D) * ((Hq * Dh) ** -0.5)),
        }
    _A_in = _A_setup()

    def _B_setup():
        B, S, D, Dff = 4, 1, 576, 4608
        return {
            "x": _w((lambda *s: torch.randn(*s, dtype=torch.bfloat16) * 0.05)(B, S, D)),
            "w1": _w((lambda *s: torch.randn(*s, dtype=torch.bfloat16) * 0.05)(D, Dff)),
            "w2": _w((lambda *s: torch.randn(*s, dtype=torch.bfloat16) * 0.05)(Dff, D)),
        }
    _B_in = _B_setup()

    return {
        "A_x": _A_in["x"],
        "A_k_cache": _A_in["k_cache"],
        "A_v_cache": _A_in["v_cache"],
        "A_wq": _A_in["wq"],
        "A_wo": _A_in["wo"],
        "B_x": _B_in["x"],
        "B_w1": _B_in["w1"],
        "B_w2": _B_in["w2"],
        "gate_w": _w((lambda *s: torch.randn(*s, dtype=torch.bfloat16) * 0.05)(576) * 16.0),
    }

def reference(A_x, A_k_cache, A_v_cache, A_wq, A_wo, B_x, B_w1, B_w2, gate_w):
    def _A_ref(x, k_cache, v_cache, wq, wo):
        B, Sq, D = x.shape
        Hq, Dh = 32, 128
        Hkv, Sk = k_cache.shape[1], k_cache.shape[2]
        W = min(4096, max(256, Sk // 4))
        rep = Hq // Hkv
        q = (lambda x, *d: x.permute(*d))((x @ wq).reshape(B, Sq, Hq, Dh), 0, 2, 1, 3)
        k = (lambda x, n, axis: torch.repeat_interleave(x, n, dim=axis))(k_cache[:, :, Sk - W:, :], rep, axis=1)
        v = (lambda x, n, axis: torch.repeat_interleave(x, n, dim=axis))(v_cache[:, :, Sk - W:, :], rep, axis=1)
        scores = torch.einsum("bhqd,bhkd->bhqk", q, k) * (Dh ** -0.5)
        p = _softmax(scores, axis=-1)
        o = torch.einsum("bhqk,bhkd->bhqd", p, v)
        return (lambda x, *d: x.permute(*d))(o, 0, 2, 1, 3).reshape(B, Sq, Hq * Dh) @ wo

    def _B_ref(x, w1, w2):
        h = torch.einsum("bsd,df->bsf", x, w1)
        zero = torch.zeros_like(h)
        h = torch.maximum(h, zero)
        return torch.einsum("bsf,fd->bsd", h, w2)

    x = A_x
    g = _sigmoid((x * gate_w).sum(-1, keepdims=True))
    a = _A_ref(x, A_k_cache, A_v_cache, A_wq, A_wo)
    b = _B_ref(x, B_w1, B_w2)
    return g * a + (1 - g) * b
```

```asm
; @launch grid=(256,1,1) block=(384,1,1) lds=163840
.amdgcn_target "amdgcn-amd-amdhsa--gfx950"
.text
.globl gated_mix__sliding_block_cached__dense_activation_relu__decode_kernel
.p2align 12
.p2align 8
.type gated_mix__sliding_block_cached__dense_activation_relu__decode_kernel,@function
gated_mix__sliding_block_cached__dense_activation_relu__decode_kernel:
    s_load_dwordx16 s[4:19], s[0:1], 0
    v_readfirstlane_b32 s3, v0
    s_lshr_b32 s29, s2, 4
    s_cmp_lg_u32 s3, 0
    s_cbranch_scc1 L_notL
    s_cmp_ge_u32 s29, 16
    s_cbranch_scc1 L_end
    s_setprio 3
    v_lshrrev_b32 v3, 3, v0
    v_and_b32 v5, 7, v0
    v_and_b32 v7, 6, v3
    v_xor_b32 v5, v5, v7
    v_lshlrev_b32 v5, 4, v5
    v_lshl_add_u32 v26, v3, 13, v5
    s_mov_b32 s41, 64512
    v_add_u32 v27, s41, v26
    v_add_u32 v28, s41, v27
    v_add_u32 v29, s41, v28
    s_lshr_b32 s50, s2, 6
    s_mulk_i32 s50, 9216
    s_and_b32 s28, s2, 15
    s_and_b32 s49, s29, 3
    s_lshl2_add_u32 s51, s28, s49
    s_add_u32 s50, s50, s51
    s_lshl_b32 s50, s50, 7
    s_mov_b32 s38, 4718592
    s_mov_b32 s39, 0x20000
    s_movk_i32 s40, 0x1000
    s_lshl_b32 s41, s40, 6
    s_mov_b32 m0, 0
    s_waitcnt lgkmcnt(0)
    s_mov_b64 s[36:37], s[10:11]

    buffer_load_dwordx4 v26, s[36:39], s50 offen offset:0 nt lds
    buffer_load_dwordx4 v27, s[36:39], s50 offen offset:1024 nt lds
    buffer_load_dwordx4 v28, s[36:39], s50 offen offset:2048 nt lds
    buffer_load_dwordx4 v29, s[36:39], s50 offen offset:3072 nt lds
    s_add_u32 m0, m0, s40
    s_add_u32 s50, s50, s41
    buffer_load_dwordx4 v26, s[36:39], s50 offen offset:0 nt lds
    buffer_load_dwordx4 v27, s[36:39], s50 offen offset:1024 nt lds
    buffer_load_dwordx4 v28, s[36:39], s50 offen offset:2048 nt lds
    buffer_load_dwordx4 v29, s[36:39], s50 offen offset:3072 nt lds
    s_add_u32 m0, m0, s40
    s_add_u32 s50, s50, s41
    buffer_load_dwordx4 v26, s[36:39], s50 offen offset:0 nt lds
    buffer_load_dwordx4 v27, s[36:39], s50 offen offset:1024 nt lds
    buffer_load_dwordx4 v28, s[36:39], s50 offen offset:2048 nt lds
    buffer_load_dwordx4 v29, s[36:39], s50 offen offset:3072 nt lds
    s_add_u32 m0, m0, s40
    s_add_u32 s50, s50, s41
    buffer_load_dwordx4 v26, s[36:39], s50 offen offset:0 nt lds
    buffer_load_dwordx4 v27, s[36:39], s50 offen offset:1024 nt lds
    buffer_load_dwordx4 v28, s[36:39], s50 offen offset:2048 nt lds
    buffer_load_dwordx4 v29, s[36:39], s50 offen offset:3072 nt lds
    s_add_u32 m0, m0, s40
    s_add_u32 s50, s50, s41
    buffer_load_dwordx4 v26, s[36:39], s50 offen offset:0 nt lds
    buffer_load_dwordx4 v27, s[36:39], s50 offen offset:1024 nt lds
    s_mov_b32 s32, s4
    s_mov_b32 s33, s5
    s_mov_b32 s34, 4608
    s_mov_b32 s35, 0x20000
    v_lshlrev_b32 v7, 4, v0
    s_mov_b32 m0, 149504
    v_and_b32 v1, 15, v0

    buffer_load_dwordx4 v7, s[32:35], 0 offen offset:0 lds
    buffer_load_dwordx4 v7, s[32:35], 0 offen offset:1024 lds
    buffer_load_dwordx4 v7, s[32:35], 0 offen offset:2048 lds
    buffer_load_dwordx4 v7, s[32:35], 0 offen offset:3072 lds
    s_add_u32 m0, m0, s40
    s_mov_b32 exec_hi, 0
    buffer_load_dwordx4 v7, s[32:35], s40 offen lds
    s_mov_b32 exec_hi, -1
    s_mov_b64 s[36:37], s[6:7]
    s_brev_b32 s38, 32
    v_lshrrev_b32 v2, 4, v0
    s_lshl_b32 s50, s49, 4
    s_add_u32 s50, s50, s28
    s_lshl_b32 s50, s50, 4
    s_lshr_b32 s51, s2, 6
    s_add_u32 s50, s50, s51
    s_add_u32 s50, s50, 12
    s_lshl_b32 s51, s50, 16
    v_xor_b32 v8, v1, v2
    v_lshlrev_b32 v8, 4, v8
    v_lshl_add_u32 v4, v2, 8, s51
    v_add_u32 v8, v8, v4
    v_xor_b32 v9, 64, v8
    v_xor_b32 v10, 0x80, v8
    v_xor_b32 v11, 0xc0, v8
    v_lshlrev_b32 v12, 1, v2
    v_xor_b32 v12, v12, v1
    v_lshl_add_u32 v12, v12, 4, v4
    v_xor_b32 v13, 0x80, v12
    v_lshlrev_b32 v15, 2, v0
    v_add_u32 v15, 157312, v15
    v_mov_b32 v6, 157248

    s_lshl_b32 s50, s29, 12
    s_mov_b32 m0, 18432
    s_mov_b32 s52, 15
    s_mov_b32 s55, 0

    s_bfe_u32 s49, s2, 0x10003
    s_mul_i32 s48, s49, 5
    s_lshr_b32 s43, s29, 1
    s_add_u32 s48, s48, s43
    s_and_b32 s43, s29, 1
    s_cmp_eq_u32 s29, 8
    s_cselect_b32 s48, 4, s48
    s_cselect_b32 s43, s49, s43

    s_and_b32 s42, s2, 7
    s_mul_i32 s42, s42, 9
    s_add_u32 s48, s48, s42
    s_lshr_b32 s49, s16, 7
    s_add_u32 s49, s49, s48
    s_and_b32 s49, s49, 7

    s_barrier
    s_cmp_ge_u32 s29, 9
    s_cbranch_scc0 L_notP
    v_mov_b32 v14, -5
L_kp:
    s_waitcnt vmcnt(20)
    v_add_u32 v14, 1, v14
    ds_write_b32 v15, v14
    buffer_load_dwordx4 v8, s[36:39], s50 offen offset:0 nt lds
    buffer_load_dwordx4 v9, s[36:39], s50 offen offset:1024 nt lds
    buffer_load_dwordx4 v10, s[36:39], s50 offen offset:2048 nt lds
    buffer_load_dwordx4 v11, s[36:39], s50 offen offset:3072 nt lds
    s_add_u32 m0, m0, s40
    s_add_u32 s50, s50, s40
    s_bitset0_b32 s50, 16
    s_sub_u32 s52, s52, 1
    s_cbranch_scc0 L_kp
    s_mov_b64 s[36:37], s[8:9]
    v_mov_b32 v8, v12
    v_mov_b32 v9, v13
    v_mov_b32 v10, v12
    v_mov_b32 v11, v13
    s_mov_b32 s52, 15
    s_xor_b32 s55, s55, 1
    s_cbranch_scc1 L_kp

    s_branch L_X
L_notP:
    s_cmp_eq_u32 s49, 3
    s_cbranch_scc0 L_notC
    v_mov_b32 v14, -7
L_kc:
    s_waitcnt vmcnt(28)
    v_add_u32 v14, 1, v14
    ds_write_b32 v15, v14
    buffer_load_dwordx4 v8, s[36:39], s50 offen offset:0 nt lds
    buffer_load_dwordx4 v9, s[36:39], s50 offen offset:1024 nt lds
    buffer_load_dwordx4 v10, s[36:39], s50 offen offset:2048 nt lds
    buffer_load_dwordx4 v11, s[36:39], s50 offen offset:3072 nt lds
    s_add_u32 m0, m0, s40
    s_add_u32 s50, s50, s40
    s_bitset0_b32 s50, 16
    s_sub_u32 s52, s52, 1
    s_cbranch_scc0 L_kc
    s_mov_b64 s[36:37], s[8:9]
    v_mov_b32 v8, v12
    v_mov_b32 v9, v13
    v_mov_b32 v10, v12
    v_mov_b32 v11, v13
    s_mov_b32 s52, 15
    s_xor_b32 s55, s55, 1
    s_cbranch_scc1 L_kc

    s_branch L_X
L_notC:
    v_mov_b32 v14, -6
L_kf:
    s_waitcnt vmcnt(24)
    v_add_u32 v14, 1, v14
    ds_write_b32 v15, v14
    buffer_load_dwordx4 v8, s[36:39], s50 offen offset:0 nt lds
    buffer_load_dwordx4 v9, s[36:39], s50 offen offset:1024 nt lds
    buffer_load_dwordx4 v10, s[36:39], s50 offen offset:2048 nt lds
    buffer_load_dwordx4 v11, s[36:39], s50 offen offset:3072 nt lds
    s_add_u32 m0, m0, s40
    s_add_u32 s50, s50, s40
    s_bitset0_b32 s50, 16
    s_sub_u32 s52, s52, 1
    s_cbranch_scc0 L_kf
    s_mov_b64 s[36:37], s[8:9]
    v_mov_b32 v8, v12
    v_mov_b32 v9, v13
    v_mov_b32 v10, v12
    v_mov_b32 v11, v13
    s_mov_b32 s52, 15
    s_xor_b32 s55, s55, 1
    s_cbranch_scc1 L_kf

L_X:
    v_mul_u32_u24 v3, 1152, v3
    v_add_u32 v16, v5, v3
    v_add_u32 v17, 8192, v16
    v_add_u32 v18, 16384, v16
    v_add_u32 v19, 24576, v16
    s_mov_b32 s53, 262144

    s_mov_b32 m0, 0
    s_cmp_ge_u32 s29, 15
    s_cbranch_scc1 L_lspare
    s_cmp_ge_u32 s29, 9
    s_cbranch_scc1 L_lP

    s_mov_b32 s32, s16
    s_mov_b32 s33, s17
    s_mov_b32 s34, 5308416
    s_mov_b32 s35, 0x20000
    s_mov_b32 s56, s18
    s_mov_b32 s57, s19
    s_mov_b32 s58, 5308416
    s_mov_b32 s59, 0x20000
    s_lshl_b32 s49, s48, 7
    s_mul_i32 s43, s43, 2654208
    s_add_u32 s49, s49, s43
    s_bfe_u32 s48, s2, 0x10003
    s_mul_i32 s48, s48, 2592
    s_mul_i32 s42, s42, 576
    s_add_u32 s48, s48, s42
    s_add_u32 s48, s48, s29
    s_lshl_b32 s48, s48, 7
    s_mov_b32 s42, 36864
    v_lshl_add_u32 v20, v3, 3, v5
    v_add_u32 v21, 72704, v20
    v_add_u32 v22, 145408, v20
    v_add_u32 v23, 218112, v20
    s_mov_b32 s41, 294912

Ls_1:
    ds_read_b32 v4, v6 offset:0
    s_sub_u32 s53, s53, 1
    s_waitcnt lgkmcnt(0)
    v_readfirstlane_b32 s54, v4
    s_cselect_b32 s54, 64, s54
    s_cmp_lt_i32 s54, 5
    s_cbranch_scc1 Ls_1

    s_waitcnt vmcnt(28)
    buffer_load_dwordx4 v20, s[32:35], s49 offen offset:0 nt lds
    buffer_load_dwordx4 v21, s[32:35], s49 offen offset:1024 nt lds
    buffer_load_dwordx4 v22, s[32:35], s49 offen offset:2048 nt lds
    buffer_load_dwordx4 v23, s[32:35], s49 offen offset:3072 nt lds
    s_add_u32 m0, m0, s40
    s_add_u32 s49, s49, s41
    s_waitcnt vmcnt(28)
    v_max_i32 v14, 27, v14
    ds_write_b32 v15, v14
    buffer_load_dwordx4 v20, s[32:35], s49 offen offset:0 nt lds
    buffer_load_dwordx4 v21, s[32:35], s49 offen offset:1024 nt lds
    buffer_load_dwordx4 v22, s[32:35], s49 offen offset:2048 nt lds
    buffer_load_dwordx4 v23, s[32:35], s49 offen offset:3072 nt lds
    s_add_u32 m0, m0, s40
    s_add_u32 s49, s49, s41
    s_waitcnt vmcnt(28)
    buffer_load_dwordx4 v20, s[32:35], s49 offen offset:0 nt lds
    buffer_load_dwordx4 v21, s[32:35], s49 offen offset:1024 nt lds
    buffer_load_dwordx4 v22, s[32:35], s49 offen offset:2048 nt lds
    buffer_load_dwordx4 v23, s[32:35], s49 offen offset:3072 nt lds
    s_add_u32 m0, m0, s40
    s_add_u32 s49, s49, s41
    s_waitcnt vmcnt(28)
    v_max_i32 v14, 29, v14
    ds_write_b32 v15, v14
    buffer_load_dwordx4 v20, s[32:35], s49 offen offset:0 nt lds
    buffer_load_dwordx4 v21, s[32:35], s49 offen offset:1024 nt lds
    buffer_load_dwordx4 v22, s[32:35], s49 offen offset:2048 nt lds
    buffer_load_dwordx4 v23, s[32:35], s49 offen offset:3072 nt lds
    s_add_u32 m0, m0, s40
    s_add_u32 s49, s49, s41
    s_waitcnt vmcnt(28)
    buffer_load_dwordx4 v20, s[32:35], s49 offen offset:0 nt lds
    buffer_load_dwordx4 v21, s[32:35], s49 offen offset:1024 nt lds
    buffer_load_dwordx4 v22, s[32:35], s49 offen offset:2048 nt lds
    buffer_load_dwordx4 v23, s[32:35], s49 offen offset:3072 nt lds
    s_add_u32 m0, m0, s40
    s_add_u32 s49, s49, s41
    s_waitcnt vmcnt(28)
    v_max_i32 v14, 31, v14
    ds_write_b32 v15, v14
    buffer_load_dwordx4 v20, s[32:35], s49 offen offset:0 nt lds
    buffer_load_dwordx4 v21, s[32:35], s49 offen offset:1024 nt lds
    buffer_load_dwordx4 v22, s[32:35], s49 offen offset:2048 nt lds
    buffer_load_dwordx4 v23, s[32:35], s49 offen offset:3072 nt lds
    s_add_u32 m0, m0, s40
    s_add_u32 s49, s49, s41
    s_waitcnt vmcnt(28)
    buffer_load_dwordx4 v20, s[32:35], s49 offen offset:0 nt lds
    buffer_load_dwordx4 v21, s[32:35], s49 offen offset:1024 nt lds
    buffer_load_dwordx4 v22, s[32:35], s49 offen offset:2048 nt lds
    buffer_load_dwordx4 v23, s[32:35], s49 offen offset:3072 nt lds
    s_add_u32 m0, m0, s40
    s_add_u32 s49, s49, s41
    s_waitcnt vmcnt(28)
    v_max_i32 v14, 33, v14
    ds_write_b32 v15, v14
    buffer_load_dwordx4 v20, s[32:35], s49 offen offset:0 nt lds
    buffer_load_dwordx4 v21, s[32:35], s49 offen offset:1024 nt lds
    buffer_load_dwordx4 v22, s[32:35], s49 offen offset:2048 nt lds
    buffer_load_dwordx4 v23, s[32:35], s49 offen offset:3072 nt lds
    s_add_u32 m0, m0, s40
    s_add_u32 s49, s49, s41
    s_waitcnt vmcnt(28)
    v_max_i32 v14, 34, v14
    ds_write_b32 v15, v14
    buffer_load_dwordx4 v20, s[32:35], s49 offen offset:0 nt lds
    buffer_load_dwordx4 v21, s[32:35], s49 offen offset:1024 nt lds
    buffer_load_dwordx4 v22, s[32:35], s49 offen offset:2048 nt lds
    buffer_load_dwordx4 v23, s[32:35], s49 offen offset:3072 nt lds
    s_add_u32 m0, m0, s40
    s_waitcnt vmcnt(28)
    v_max_i32 v14, 35, v14
    ds_write_b32 v15, v14
    s_waitcnt vmcnt(24)
    v_max_i32 v14, 36, v14
    ds_write_b32 v15, v14
    s_waitcnt vmcnt(20)
    v_max_i32 v14, 37, v14
    ds_write_b32 v15, v14
    buffer_load_dwordx4 v16, s[56:59], s48 offen offset:0 nt lds
    buffer_load_dwordx4 v17, s[56:59], s48 offen offset:1024 nt lds
    buffer_load_dwordx4 v18, s[56:59], s48 offen offset:2048 nt lds
    buffer_load_dwordx4 v19, s[56:59], s48 offen offset:3072 nt lds
    s_add_u32 m0, m0, s40
    s_add_u32 s48, s48, s42
    s_waitcnt vmcnt(20)
    v_max_i32 v14, 38, v14
    ds_write_b32 v15, v14
    buffer_load_dwordx4 v16, s[56:59], s48 offen offset:0 nt lds
    buffer_load_dwordx4 v17, s[56:59], s48 offen offset:1024 nt lds
    buffer_load_dwordx4 v18, s[56:59], s48 offen offset:2048 nt lds
    buffer_load_dwordx4 v19, s[56:59], s48 offen offset:3072 nt lds
    s_add_u32 m0, m0, s40
    s_add_u32 s48, s48, s42
    s_waitcnt vmcnt(20)
    v_max_i32 v14, 39, v14
    ds_write_b32 v15, v14
    buffer_load_dwordx4 v16, s[56:59], s48 offen offset:0 nt lds
    buffer_load_dwordx4 v17, s[56:59], s48 offen offset:1024 nt lds
    buffer_load_dwordx4 v18, s[56:59], s48 offen offset:2048 nt lds
    buffer_load_dwordx4 v19, s[56:59], s48 offen offset:3072 nt lds
    s_add_u32 m0, m0, s40
    s_add_u32 s48, s48, s42
    s_waitcnt vmcnt(20)
    v_max_i32 v14, 40, v14
    ds_write_b32 v15, v14
    buffer_load_dwordx4 v16, s[56:59], s48 offen offset:0 nt lds
    buffer_load_dwordx4 v17, s[56:59], s48 offen offset:1024 nt lds
    buffer_load_dwordx4 v18, s[56:59], s48 offen offset:2048 nt lds
    buffer_load_dwordx4 v19, s[56:59], s48 offen offset:3072 nt lds
    s_add_u32 m0, m0, s40
    s_add_u32 s48, s48, s42
    s_waitcnt vmcnt(20)
    v_max_i32 v14, 41, v14
    ds_write_b32 v15, v14
    buffer_load_dwordx4 v16, s[56:59], s48 offen offset:0 nt lds
    buffer_load_dwordx4 v17, s[56:59], s48 offen offset:1024 nt lds
    buffer_load_dwordx4 v18, s[56:59], s48 offen offset:2048 nt lds
    buffer_load_dwordx4 v19, s[56:59], s48 offen offset:3072 nt lds
    s_add_u32 m0, m0, s40
    s_add_u32 s48, s48, s42
    s_waitcnt vmcnt(20)
    v_max_i32 v14, 42, v14
    ds_write_b32 v15, v14
    buffer_load_dwordx4 v16, s[56:59], s48 offen offset:0 nt lds
    buffer_load_dwordx4 v17, s[56:59], s48 offen offset:1024 nt lds
    buffer_load_dwordx4 v18, s[56:59], s48 offen offset:2048 nt lds
    buffer_load_dwordx4 v19, s[56:59], s48 offen offset:3072 nt lds
    s_add_u32 m0, m0, s40
    s_add_u32 s48, s48, s42
    s_waitcnt vmcnt(20)
    v_max_i32 v14, 43, v14
    ds_write_b32 v15, v14
    buffer_load_dwordx4 v16, s[56:59], s48 offen offset:0 nt lds
    buffer_load_dwordx4 v17, s[56:59], s48 offen offset:1024 nt lds
    buffer_load_dwordx4 v18, s[56:59], s48 offen offset:2048 nt lds
    buffer_load_dwordx4 v19, s[56:59], s48 offen offset:3072 nt lds
    s_add_u32 m0, m0, s40
    s_add_u32 s48, s48, s42
    s_waitcnt vmcnt(20)
    v_max_i32 v14, 44, v14
    ds_write_b32 v15, v14
    buffer_load_dwordx4 v16, s[56:59], s48 offen offset:0 nt lds
    buffer_load_dwordx4 v17, s[56:59], s48 offen offset:1024 nt lds
    buffer_load_dwordx4 v18, s[56:59], s48 offen offset:2048 nt lds
    buffer_load_dwordx4 v19, s[56:59], s48 offen offset:3072 nt lds
    s_add_u32 m0, m0, s40
    s_add_u32 s48, s48, s42
    s_waitcnt vmcnt(20)
    v_max_i32 v14, 45, v14
    ds_write_b32 v15, v14
    buffer_load_dwordx4 v16, s[56:59], s48 offen offset:0 nt lds
    buffer_load_dwordx4 v17, s[56:59], s48 offen offset:1024 nt lds
    buffer_load_dwordx4 v18, s[56:59], s48 offen offset:2048 nt lds
    buffer_load_dwordx4 v19, s[56:59], s48 offen offset:3072 nt lds
    s_waitcnt vmcnt(20)
    v_max_i32 v14, 46, v14
    ds_write_b32 v15, v14
    s_waitcnt vmcnt(16)
    v_max_i32 v14, 47, v14
    ds_write_b32 v15, v14
    s_waitcnt vmcnt(12)
    v_max_i32 v14, 48, v14
    ds_write_b32 v15, v14
    s_waitcnt vmcnt(8)
    v_max_i32 v14, 49, v14
    ds_write_b32 v15, v14
    s_waitcnt vmcnt(4)
    v_max_i32 v14, 50, v14
    ds_write_b32 v15, v14
    s_waitcnt vmcnt(0)
    v_max_i32 v14, 51, v14
    ds_write_b32 v15, v14
    s_endpgm
    .p2align 12
L_notL:
    s_cmp_ge_u32 s29, 16
    s_cbranch_scc1 L_end
    s_load_dwordx8 s[20:27], s[0:1], 64
    v_and_b32 v0, 63, v0
    v_lshlrev_b32 v3, 2, v0
    v_add_u32 v3, 157248, v3
    v_mov_b32 v4, 0
    ds_write2_b32 v3, v4, v4 offset0:0 offset1:16
    s_lshr_b32 s3, s3, 6
    s_and_b32 s28, s2, 15
    v_and_b32 v1, 15, v0
    v_lshrrev_b32 v2, 4, v0
    v_mov_b32 v6, 157248
    v_mov_b32 v7, 1
    s_waitcnt lgkmcnt(0)
    s_load_dword s30, s[26:27], 0
    s_barrier

    s_cmp_eq_u32 s3, 3
    s_cbranch_scc1 W_lp
    s_cmp_eq_u32 s3, 4
    s_cbranch_scc1 W_p0
    s_cmp_eq_u32 s3, 5
    s_cbranch_scc1 W_g0
    s_cmp_lg_u32 s3, 1
    s_cbranch_scc1 L_KV
L_Q:
    s_setprio 2
    s_mov_b32 s44, s26
    s_mov_b32 s45, s27
    s_mov_b32 s46, 268435456
    s_mov_b32 s47, 0x20000
    v_lshrrev_b32 v27, 2, v0
    v_lshlrev_b32 v26, 7, v27
    v_bfe_u32 v27, v0, 3, 2
    v_lshl_add_u32 v26, v27, 5, v26
    v_and_b32 v27, 3, v0
    v_lshl_add_u32 v26, v27, 3, v26

    v_xor_b32 v27, 32, v26
    v_xor_b32 v28, 64, v26
    v_xor_b32 v29, 96, v26
    s_lshr_b32 s48, s29, 2
    s_and_b32 s49, s29, 3
    v_and_b32 v3, 3, v1
    v_lshlrev_b32 v30, 12, v3
    v_mul_u32_u24 v3, 1152, v3
    v_add_u32 v3, 149504, v3
    s_mul_i32 s51, s48, 288
    v_lshl_add_u32 v204, v2, 3, v3
    v_add_u32 v3, s51, v204
    v_lshrrev_b32 v8, 2, v1
    v_lshl_add_u32 v30, v8, 6, v30
    v_lshl_add_u32 v30, v2, 4, v30
    v_lshlrev_b32 v31, 4, v0
    s_lshl_b32 s50, s28, 14
    s_add_u32 s50, s50, 65536
    s_lshl_b32 s51, s49, 12
    s_add_u32 s52, s50, s51
    s_lshl_b32 s51, s48, 10
    s_add_u32 s50, s50, s51
    s_lshl_b32 s51, s49, 8
    s_add_u32 s50, s50, s51
    s_mov_b32 s53, 262144
    s_getreg_b32 s31, hwreg(HW_REG_XCC_ID, 0, 3)
    s_waitcnt lgkmcnt(0)
    s_add_u32 s30, s30, 2654435769
    s_xor_b32 s31, s31, s30

Ls_3:
    ds_read_b32 v5, v6 offset:64
    ds_read2_b64 v[8:11], v3 offset0:0 offset1:4
    ds_read2_b64 v[12:15], v3 offset0:8 offset1:12
    ds_read2_b64 v[16:19], v3 offset0:16 offset1:20
    ds_read2_b64 v[20:23], v3 offset0:24 offset1:28
    ds_read_b64 v[24:25], v3 offset:256
    ds_read_b64_tr_b16 v[32:33], v26 offset:0
    ds_read_b64_tr_b16 v[34:35], v26 offset:2048
    ds_read_b64_tr_b16 v[36:37], v27 offset:0
    ds_read_b64_tr_b16 v[38:39], v27 offset:2048
    ds_read_b64_tr_b16 v[40:41], v28 offset:0
    ds_read_b64_tr_b16 v[42:43], v28 offset:2048
    ds_read_b64_tr_b16 v[44:45], v29 offset:0
    ds_read_b64_tr_b16 v[46:47], v29 offset:2048
    s_sub_u32 s53, s53, 1
    s_waitcnt lgkmcnt(13)
    v_readfirstlane_b32 s54, v5
    s_cselect_b32 s54, 64, s54
    s_cmp_lt_i32 s54, 1
    s_cbranch_scc1 Ls_3

    s_waitcnt lgkmcnt(0)
    ds_read_b64_tr_b16 v[48:49], v26 offset:4096
    ds_read_b64_tr_b16 v[50:51], v26 offset:6144
    ds_read_b64_tr_b16 v[52:53], v27 offset:4096
    ds_read_b64_tr_b16 v[54:55], v27 offset:6144
    ds_read_b64_tr_b16 v[56:57], v28 offset:4096
    ds_read_b64_tr_b16 v[58:59], v28 offset:6144
    ds_read_b64_tr_b16 v[60:61], v29 offset:4096
    ds_read_b64_tr_b16 v[62:63], v29 offset:6144
    v_mfma_f32_16x16x32_bf16 v[112:115], v[32:35], v[8:11], 0
    v_mfma_f32_16x16x32_bf16 v[116:119], v[36:39], v[8:11], 0
    v_mfma_f32_16x16x32_bf16 v[120:123], v[40:43], v[8:11], 0
    v_mfma_f32_16x16x32_bf16 v[124:127], v[44:47], v[8:11], 0
    s_waitcnt lgkmcnt(0)
    ds_read_b64_tr_b16 v[64:65], v26 offset:8192
    ds_read_b64_tr_b16 v[66:67], v26 offset:10240
    ds_read_b64_tr_b16 v[68:69], v27 offset:8192
    ds_read_b64_tr_b16 v[70:71], v27 offset:10240
    ds_read_b64_tr_b16 v[72:73], v28 offset:8192
    ds_read_b64_tr_b16 v[74:75], v28 offset:10240
    ds_read_b64_tr_b16 v[76:77], v29 offset:8192
    ds_read_b64_tr_b16 v[78:79], v29 offset:10240
    v_mfma_f32_16x16x32_bf16 v[112:115], v[48:51], v[12:15], v[112:115]
    v_mfma_f32_16x16x32_bf16 v[116:119], v[52:55], v[12:15], v[116:119]
    v_mfma_f32_16x16x32_bf16 v[120:123], v[56:59], v[12:15], v[120:123]
    v_mfma_f32_16x16x32_bf16 v[124:127], v[60:63], v[12:15], v[124:127]
    s_waitcnt lgkmcnt(0)
    ds_read_b64_tr_b16 v[80:81], v26 offset:12288
    ds_read_b64_tr_b16 v[82:83], v26 offset:14336
    ds_read_b64_tr_b16 v[84:85], v27 offset:12288
    ds_read_b64_tr_b16 v[86:87], v27 offset:14336
    ds_read_b64_tr_b16 v[88:89], v28 offset:12288
    ds_read_b64_tr_b16 v[90:91], v28 offset:14336
    ds_read_b64_tr_b16 v[92:93], v29 offset:12288
    ds_read_b64_tr_b16 v[94:95], v29 offset:14336
    v_mfma_f32_16x16x32_bf16 v[112:115], v[64:67], v[16:19], v[112:115]
    v_mfma_f32_16x16x32_bf16 v[116:119], v[68:71], v[16:19], v[116:119]
    v_mfma_f32_16x16x32_bf16 v[120:123], v[72:75], v[16:19], v[120:123]
    v_mfma_f32_16x16x32_bf16 v[124:127], v[76:79], v[16:19], v[124:127]
    s_waitcnt lgkmcnt(0)
    ds_read_b64_tr_b16 v[96:97], v26 offset:16384
    ds_read_b64_tr_b16 v[98:99], v27 offset:16384
    ds_read_b64_tr_b16 v[100:101], v28 offset:16384
    ds_read_b64_tr_b16 v[102:103], v29 offset:16384
    s_mov_b64 exec, 1
    ds_add_u32 v6, v7 offset:0
    s_mov_b64 exec, -1
    v_mfma_f32_16x16x32_bf16 v[112:115], v[80:83], v[20:23], v[112:115]
    v_mfma_f32_16x16x32_bf16 v[116:119], v[84:87], v[20:23], v[116:119]
    v_mfma_f32_16x16x32_bf16 v[120:123], v[88:91], v[20:23], v[120:123]
    v_mfma_f32_16x16x32_bf16 v[124:127], v[92:95], v[20:23], v[124:127]
    s_waitcnt lgkmcnt(1)
    s_nop 1
    v_mfma_f32_16x16x16_bf16 v[112:115], v[96:97], v[24:25], v[112:115]
    v_mfma_f32_16x16x16_bf16 v[116:119], v[98:99], v[24:25], v[116:119]
    v_mfma_f32_16x16x16_bf16 v[120:123], v[100:101], v[24:25], v[120:123]
    v_mfma_f32_16x16x16_bf16 v[124:127], v[102:103], v[24:25], v[124:127]
    s_nop 5
    v_mov_b32_dpp v112, v116 quad_perm:[0,1,2,3] row_mask:0xf bank_mask:0x2
    v_mov_b32_dpp v113, v117 quad_perm:[0,1,2,3] row_mask:0xf bank_mask:0x2
    v_mov_b32_dpp v114, v118 quad_perm:[0,1,2,3] row_mask:0xf bank_mask:0x2
    v_mov_b32_dpp v115, v119 quad_perm:[0,1,2,3] row_mask:0xf bank_mask:0x2
    v_mov_b32_dpp v112, v120 quad_perm:[0,1,2,3] row_mask:0xf bank_mask:0x4
    v_mov_b32_dpp v113, v121 quad_perm:[0,1,2,3] row_mask:0xf bank_mask:0x4
    v_mov_b32_dpp v114, v122 quad_perm:[0,1,2,3] row_mask:0xf bank_mask:0x4
    v_mov_b32_dpp v115, v123 quad_perm:[0,1,2,3] row_mask:0xf bank_mask:0x4
    v_mov_b32_dpp v112, v124 quad_perm:[0,1,2,3] row_mask:0xf bank_mask:0x8
    v_mov_b32_dpp v113, v125 quad_perm:[0,1,2,3] row_mask:0xf bank_mask:0x8
    v_mov_b32_dpp v114, v126 quad_perm:[0,1,2,3] row_mask:0xf bank_mask:0x8
    v_mov_b32_dpp v115, v127 quad_perm:[0,1,2,3] row_mask:0xf bank_mask:0x8
    v_mov_b32_sdwa v112, s30 dst_sel:BYTE_0 dst_unused:UNUSED_PRESERVE src0_sel:BYTE_0
    v_mov_b32_sdwa v113, s30 dst_sel:BYTE_0 dst_unused:UNUSED_PRESERVE src0_sel:BYTE_0
    v_mov_b32_sdwa v114, s30 dst_sel:BYTE_0 dst_unused:UNUSED_PRESERVE src0_sel:BYTE_0
    v_mov_b32_sdwa v115, s31 dst_sel:BYTE_0 dst_unused:UNUSED_PRESERVE src0_sel:BYTE_0
    buffer_store_dwordx4 v[112:115], v30, s[44:47], s50 offen
Ls_5:
    ds_read_b32 v5, v6 offset:64
    s_sub_u32 s53, s53, 1
    s_waitcnt lgkmcnt(0)
    v_readfirstlane_b32 s54, v5
    s_cselect_b32 s54, 64, s54
    s_cmp_lt_i32 s54, 9
    s_cbranch_scc1 Ls_5

    s_mov_b32 s55, 32768
L_qpoll:
    buffer_load_dwordx4 v[32:35], v31, s[44:47], s52 offen offset:0 sc1
    buffer_load_dwordx4 v[36:39], v31, s[44:47], s52 offen offset:1024 sc1
    buffer_load_dwordx4 v[40:43], v31, s[44:47], s52 offen offset:2048 sc1
    buffer_load_dwordx4 v[44:47], v31, s[44:47], s52 offen offset:3072 sc1
L_qchk:
    s_waitcnt vmcnt(0)
    v_bitop3_b32 v48, v32, v33, s30 bitop3:0x7e
    v_bitop3_b32 v49, v36, v37, s30 bitop3:0x7e
    v_bitop3_b32 v50, v40, v41, s30 bitop3:0x7e
    v_bitop3_b32 v51, v44, v45, s30 bitop3:0x7e
    v_bitop3_b32 v52, v34, v38, s30 bitop3:0x7e
    v_bitop3_b32 v53, v42, v46, s30 bitop3:0x7e
    v_bitop3_b32 v54, v35, v39, s31 bitop3:0x7e
    v_bitop3_b32 v55, v43, v47, s31 bitop3:0x7e
    v_or3_b32 v48, v48, v49, v50
    v_or_b32 v54, v54, v55
    v_or3_b32 v51, v51, v52, v53
    v_and_b32 v55, -8, v54
    v_or3_b32 v48, v48, v51, v55
    s_nop 1
    v_or_b32_dpp v48, v48, v48 quad_perm:[1,0,3,2] row_mask:0xf bank_mask:0xf
    s_nop 1
    v_or_b32_dpp v48, v48, v48 quad_perm:[2,3,0,1] row_mask:0xf bank_mask:0xf
    v_cmp_ne_u32_sdwa vcc, v48, 0 src0_sel:BYTE_0 src1_sel:DWORD
    s_sub_u32 s55, s55, 1
    s_cbranch_scc1 L_qgot
    s_cmp_lg_u32 s55, 32764
    s_cbranch_scc1 L_qnofb
    s_mov_b64 exec, -1
    buffer_store_dwordx4 v[112:115], v30, s[44:47], s50 offen sc1
L_qnofb:
    s_mov_b64 exec, vcc
    s_cbranch_execnz L_qpoll
L_qgot:
    s_mov_b64 exec, -1
    v_and_b32 v54, 7, v54
    v_cmp_ne_u32 vcc, 0, v54
    s_mov_b32 s34, 1
    s_cbranch_vccz L_qpure
    s_mov_b32 s34, 2
    buffer_store_dwordx4 v[112:115], v30, s[44:47], s50 offen sc1
L_qpure:

    v_mov_b32 v54, s34

    v_add_f32 v32, v32, v36
    v_add_f32 v40, v40, v44
    v_add_f32 v33, v33, v37
    v_add_f32 v41, v41, v45
    v_add_f32 v34, v34, v38
    v_add_f32 v42, v42, v46
    v_add_f32 v35, v35, v39
    v_add_f32 v43, v43, v47
    v_add_f32 v32, v32, v40
    v_add_f32 v33, v33, v41
    v_add_f32 v34, v34, v42
    v_add_f32 v35, v35, v43
    v_cvt_pk_bf16_f32 v32, v32, v33
    v_cvt_pk_bf16_f32 v33, v34, v35
    v_lshlrev_b32 v3, 3, v0
    v_add_u32 v3, 154624, v3
    ds_write_b64 v3, v[32:33]
    s_mov_b64 exec, 1
    ds_write_b32 v6, v54 offset:4
    s_mov_b64 exec, -1

    s_cmp_lt_u32 s29, 9
    s_cbranch_scc1 L_ffn

    s_endpgm
L_ffn:
    s_bfe_u32 s51, s2, 0x10003
    s_mul_i32 s48, s51, 5
    s_lshr_b32 s49, s29, 1
    s_add_u32 s48, s48, s49
    s_and_b32 s49, s29, 1
    s_cmp_eq_u32 s29, 8
    s_cselect_b32 s48, 4, s48
    s_cselect_b32 s49, s51, s49

    s_mul_i32 s52, s49, 576
    v_add_u32 v204, s52, v204

    ds_read2_b64 v[32:35], v204 offset0:0 offset1:4
    ds_read2_b64 v[36:39], v204 offset0:8 offset1:12
    ds_read2_b64 v[40:43], v204 offset0:16 offset1:20
    ds_read2_b64 v[44:47], v204 offset0:24 offset1:28
    ds_read2_b64 v[48:51], v204 offset0:32 offset1:36
    ds_read2_b64 v[52:55], v204 offset0:40 offset1:44
    ds_read2_b64 v[56:59], v204 offset0:48 offset1:52
    ds_read2_b64 v[60:63], v204 offset0:56 offset1:60
    ds_read2_b64 v[64:67], v204 offset0:64 offset1:68

    v_and_b32 v4, 7, v0
    v_lshlrev_b32 v200, 4, v4
    v_lshl_add_u32 v200, v2, 7, v200
    v_and_b32 v4, 8, v0
    v_lshl_add_u32 v200, v4, 6, v200
    v_and_b32 v4, 3, v0
    v_lshlrev_b32 v202, 4, v4
    v_and_b32 v4, 4, v0
    v_lshl_add_u32 v202, v4, 1, v202
    v_and_b32 v4, 0x38, v0
    v_lshl_add_u32 v202, v4, 3, v202
    v_add_u32 v202, 149504, v202

    s_and_b32 s50, s2, 7
    s_lshl_b32 s50, s50, 15
    s_add_u32 s50, s50, 655360
    s_mul_i32 s52, s49, 9
    s_add_u32 s52, s52, s48
    s_lshl_b32 s52, s52, 10
    s_add_u32 s52, s52, s50
    s_mul_i32 s51, s51, 4608
    s_add_u32 s48, s50, s51
    s_add_u32 s49, s48, 4096
    s_add_u32 s50, s48, 9216
    s_add_u32 s51, s49, 9216

    v_not_b32 v112, s30
    v_mov_b32 v113, v112
    v_mov_b32 v114, v112
    v_mov_b32 v115, v112
    buffer_store_dwordx4 v[112:115], v200, s[44:47], s52 offen
    s_cmp_lg_u32 s29, 8
    s_cbranch_scc1 L_np8
    s_xor_b32 s55, s28, 8
    s_lshl_b32 s55, s55, 14
    s_add_u32 s55, s55, 65536
    v_lshlrev_b32 v8, 8, v1
    buffer_load_dwordx4 v[8:11], v8, s[44:47], s55 offen sc1
    s_waitcnt vmcnt(0)
    v_bitop3_b32 v8, v8, v9, s30 bitop3:0x7e
    v_xor_b32 v10, s30, v10
    v_xor_b32 v11, s31, v11
    v_or3_b32 v8, v8, v10, v11
    v_cmp_ne_u32_sdwa vcc, v8, 0 src0_sel:BYTE_0 src1_sel:DWORD
    s_cbranch_vccz L_np8
    s_mov_b32 s34, 2
L_np8:

    s_waitcnt lgkmcnt(0)
S_f0:
Ls_7:
    ds_read_b32 v5, v6 offset:64
    ds_read_b64_tr_b16 v[80:81], v26 offset:0
    ds_read_b64_tr_b16 v[82:83], v26 offset:2048
    ds_read_b64_tr_b16 v[84:85], v27 offset:0
    ds_read_b64_tr_b16 v[86:87], v27 offset:2048
    ds_read_b64_tr_b16 v[88:89], v28 offset:0
    ds_read_b64_tr_b16 v[90:91], v28 offset:2048
    ds_read_b64_tr_b16 v[92:93], v29 offset:0
    ds_read_b64_tr_b16 v[94:95], v29 offset:2048
    s_sub_u32 s53, s53, 1
    s_waitcnt lgkmcnt(8)
    v_readfirstlane_b32 s54, v5
    s_cselect_b32 s54, 64, s54
    s_cmp_lt_i32 s54, 34
    s_cbranch_scc1 Ls_7

    s_waitcnt lgkmcnt(6)
    v_mfma_f32_16x16x32_bf16 v[112:115], v[80:83], v[32:35], 0
    s_waitcnt lgkmcnt(4)
    v_mfma_f32_16x16x32_bf16 v[116:119], v[84:87], v[32:35], 0
    s_waitcnt lgkmcnt(2)
    v_mfma_f32_16x16x32_bf16 v[120:123], v[88:91], v[32:35], 0
    s_waitcnt lgkmcnt(0)
    v_mfma_f32_16x16x32_bf16 v[124:127], v[92:95], v[32:35], 0
S_f1:
Ls_9:
    ds_read_b32 v5, v6 offset:64
    ds_read_b64_tr_b16 v[96:97], v26 offset:4096
    ds_read_b64_tr_b16 v[98:99], v26 offset:6144
    ds_read_b64_tr_b16 v[100:101], v27 offset:4096
    ds_read_b64_tr_b16 v[102:103], v27 offset:6144
    ds_read_b64_tr_b16 v[104:105], v28 offset:4096
    ds_read_b64_tr_b16 v[106:107], v28 offset:6144
    ds_read_b64_tr_b16 v[108:109], v29 offset:4096
    ds_read_b64_tr_b16 v[110:111], v29 offset:6144
    s_sub_u32 s53, s53, 1
    s_waitcnt lgkmcnt(8)
    v_readfirstlane_b32 s54, v5
    s_cselect_b32 s54, 64, s54
    s_cmp_lt_i32 s54, 35
    s_cbranch_scc1 Ls_9

    s_waitcnt lgkmcnt(6)
    v_mfma_f32_16x16x32_bf16 v[112:115], v[96:99], v[36:39], v[112:115]
    s_waitcnt lgkmcnt(4)
    v_mfma_f32_16x16x32_bf16 v[116:119], v[100:103], v[36:39], v[116:119]
    s_waitcnt lgkmcnt(2)
    v_mfma_f32_16x16x32_bf16 v[120:123], v[104:107], v[36:39], v[120:123]
    s_waitcnt lgkmcnt(0)
    v_mfma_f32_16x16x32_bf16 v[124:127], v[108:111], v[36:39], v[124:127]
S_f2:
Ls_11:
    ds_read_b32 v5, v6 offset:64
    ds_read_b64_tr_b16 v[80:81], v26 offset:8192
    ds_read_b64_tr_b16 v[82:83], v26 offset:10240
    ds_read_b64_tr_b16 v[84:85], v27 offset:8192
    ds_read_b64_tr_b16 v[86:87], v27 offset:10240
    ds_read_b64_tr_b16 v[88:89], v28 offset:8192
    ds_read_b64_tr_b16 v[90:91], v28 offset:10240
    ds_read_b64_tr_b16 v[92:93], v29 offset:8192
    ds_read_b64_tr_b16 v[94:95], v29 offset:10240
    s_sub_u32 s53, s53, 1
    s_waitcnt lgkmcnt(8)
    v_readfirstlane_b32 s54, v5
    s_cselect_b32 s54, 64, s54
    s_cmp_lt_i32 s54, 36
    s_cbranch_scc1 Ls_11

    s_waitcnt lgkmcnt(6)
    v_mfma_f32_16x16x32_bf16 v[112:115], v[80:83], v[40:43], v[112:115]
    s_waitcnt lgkmcnt(4)
    v_mfma_f32_16x16x32_bf16 v[116:119], v[84:87], v[40:43], v[116:119]
    s_waitcnt lgkmcnt(2)
    v_mfma_f32_16x16x32_bf16 v[120:123], v[88:91], v[40:43], v[120:123]
    s_waitcnt lgkmcnt(0)
    v_mfma_f32_16x16x32_bf16 v[124:127], v[92:95], v[40:43], v[124:127]
S_f3:
Ls_13:
    ds_read_b32 v5, v6 offset:64
    ds_read_b64_tr_b16 v[96:97], v26 offset:12288
    ds_read_b64_tr_b16 v[98:99], v26 offset:14336
    ds_read_b64_tr_b16 v[100:101], v27 offset:12288
    ds_read_b64_tr_b16 v[102:103], v27 offset:14336
    ds_read_b64_tr_b16 v[104:105], v28 offset:12288
    ds_read_b64_tr_b16 v[106:107], v28 offset:14336
    ds_read_b64_tr_b16 v[108:109], v29 offset:12288
    ds_read_b64_tr_b16 v[110:111], v29 offset:14336
    s_sub_u32 s53, s53, 1
    s_waitcnt lgkmcnt(8)
    v_readfirstlane_b32 s54, v5
    s_cselect_b32 s54, 64, s54
    s_cmp_lt_i32 s54, 37
    s_cbranch_scc1 Ls_13

    s_waitcnt lgkmcnt(6)
    v_mfma_f32_16x16x32_bf16 v[112:115], v[96:99], v[44:47], v[112:115]
    s_waitcnt lgkmcnt(4)
    v_mfma_f32_16x16x32_bf16 v[116:119], v[100:103], v[44:47], v[116:119]
    s_waitcnt lgkmcnt(2)
    v_mfma_f32_16x16x32_bf16 v[120:123], v[104:107], v[44:47], v[120:123]
    s_waitcnt lgkmcnt(0)
    v_mfma_f32_16x16x32_bf16 v[124:127], v[108:111], v[44:47], v[124:127]
S_f4:
Ls_15:
    ds_read_b32 v5, v6 offset:64
    ds_read_b64_tr_b16 v[80:81], v26 offset:16384
    ds_read_b64_tr_b16 v[82:83], v26 offset:18432
    ds_read_b64_tr_b16 v[84:85], v27 offset:16384
    ds_read_b64_tr_b16 v[86:87], v27 offset:18432
    ds_read_b64_tr_b16 v[88:89], v28 offset:16384
    ds_read_b64_tr_b16 v[90:91], v28 offset:18432
    ds_read_b64_tr_b16 v[92:93], v29 offset:16384
    ds_read_b64_tr_b16 v[94:95], v29 offset:18432
    s_sub_u32 s53, s53, 1
    s_waitcnt lgkmcnt(8)
    v_readfirstlane_b32 s54, v5
    s_cselect_b32 s54, 64, s54
    s_cmp_lt_i32 s54, 38
    s_cbranch_scc1 Ls_15

    s_waitcnt lgkmcnt(6)
    v_mfma_f32_16x16x32_bf16 v[112:115], v[80:83], v[48:51], v[112:115]
    s_waitcnt lgkmcnt(4)
    v_mfma_f32_16x16x32_bf16 v[116:119], v[84:87], v[48:51], v[116:119]
    s_waitcnt lgkmcnt(2)
    v_mfma_f32_16x16x32_bf16 v[120:123], v[88:91], v[48:51], v[120:123]
    s_waitcnt lgkmcnt(0)
    v_mfma_f32_16x16x32_bf16 v[124:127], v[92:95], v[48:51], v[124:127]
S_f5:
Ls_17:
    ds_read_b32 v5, v6 offset:64
    ds_read_b64_tr_b16 v[96:97], v26 offset:20480
    ds_read_b64_tr_b16 v[98:99], v26 offset:22528
    ds_read_b64_tr_b16 v[100:101], v27 offset:20480
    ds_read_b64_tr_b16 v[102:103], v27 offset:22528
    ds_read_b64_tr_b16 v[104:105], v28 offset:20480
    ds_read_b64_tr_b16 v[106:107], v28 offset:22528
    ds_read_b64_tr_b16 v[108:109], v29 offset:20480
    ds_read_b64_tr_b16 v[110:111], v29 offset:22528
    s_sub_u32 s53, s53, 1
    s_waitcnt lgkmcnt(8)
    v_readfirstlane_b32 s54, v5
    s_cselect_b32 s54, 64, s54
    s_cmp_lt_i32 s54, 39
    s_cbranch_scc1 Ls_17

    s_waitcnt lgkmcnt(6)
    v_mfma_f32_16x16x32_bf16 v[112:115], v[96:99], v[52:55], v[112:115]
    s_waitcnt lgkmcnt(4)
    v_mfma_f32_16x16x32_bf16 v[116:119], v[100:103], v[52:55], v[116:119]
    s_waitcnt lgkmcnt(2)
    v_mfma_f32_16x16x32_bf16 v[120:123], v[104:107], v[52:55], v[120:123]
    s_waitcnt lgkmcnt(0)
    v_mfma_f32_16x16x32_bf16 v[124:127], v[108:111], v[52:55], v[124:127]
S_f6:
Ls_19:
    ds_read_b32 v5, v6 offset:64
    ds_read_b64_tr_b16 v[80:81], v26 offset:24576
    ds_read_b64_tr_b16 v[82:83], v26 offset:26624
    ds_read_b64_tr_b16 v[84:85], v27 offset:24576
    ds_read_b64_tr_b16 v[86:87], v27 offset:26624
    ds_read_b64_tr_b16 v[88:89], v28 offset:24576
    ds_read_b64_tr_b16 v[90:91], v28 offset:26624
    ds_read_b64_tr_b16 v[92:93], v29 offset:24576
    ds_read_b64_tr_b16 v[94:95], v29 offset:26624
    s_sub_u32 s53, s53, 1
    s_waitcnt lgkmcnt(8)
    v_readfirstlane_b32 s54, v5
    s_cselect_b32 s54, 64, s54
    s_cmp_lt_i32 s54, 40
    s_cbranch_scc1 Ls_19

    s_waitcnt lgkmcnt(6)
    v_mfma_f32_16x16x32_bf16 v[112:115], v[80:83], v[56:59], v[112:115]
    s_waitcnt lgkmcnt(4)
    v_mfma_f32_16x16x32_bf16 v[116:119], v[84:87], v[56:59], v[116:119]
    s_waitcnt lgkmcnt(2)
    v_mfma_f32_16x16x32_bf16 v[120:123], v[88:91], v[56:59], v[120:123]
    s_waitcnt lgkmcnt(0)
    v_mfma_f32_16x16x32_bf16 v[124:127], v[92:95], v[56:59], v[124:127]
S_f7:
Ls_21:
    ds_read_b32 v5, v6 offset:64
    ds_read_b64_tr_b16 v[96:97], v26 offset:28672
    ds_read_b64_tr_b16 v[98:99], v26 offset:30720
    ds_read_b64_tr_b16 v[100:101], v27 offset:28672
    ds_read_b64_tr_b16 v[102:103], v27 offset:30720
    ds_read_b64_tr_b16 v[104:105], v28 offset:28672
    ds_read_b64_tr_b16 v[106:107], v28 offset:30720
    ds_read_b64_tr_b16 v[108:109], v29 offset:28672
    ds_read_b64_tr_b16 v[110:111], v29 offset:30720
    s_sub_u32 s53, s53, 1
    s_waitcnt lgkmcnt(8)
    v_readfirstlane_b32 s54, v5
    s_cselect_b32 s54, 64, s54
    s_cmp_lt_i32 s54, 41
    s_cbranch_scc1 Ls_21

    s_waitcnt lgkmcnt(6)
    v_mfma_f32_16x16x32_bf16 v[112:115], v[96:99], v[60:63], v[112:115]
    s_waitcnt lgkmcnt(4)
    v_mfma_f32_16x16x32_bf16 v[116:119], v[100:103], v[60:63], v[116:119]
    s_waitcnt lgkmcnt(2)
    v_mfma_f32_16x16x32_bf16 v[120:123], v[104:107], v[60:63], v[120:123]
    s_waitcnt lgkmcnt(0)
    v_mfma_f32_16x16x32_bf16 v[124:127], v[108:111], v[60:63], v[124:127]
S_f8:
Ls_23:
    ds_read_b32 v5, v6 offset:64
    ds_read_b64_tr_b16 v[80:81], v26 offset:32768
    ds_read_b64_tr_b16 v[82:83], v26 offset:34816
    ds_read_b64_tr_b16 v[84:85], v27 offset:32768
    ds_read_b64_tr_b16 v[86:87], v27 offset:34816
    ds_read_b64_tr_b16 v[88:89], v28 offset:32768
    ds_read_b64_tr_b16 v[90:91], v28 offset:34816
    ds_read_b64_tr_b16 v[92:93], v29 offset:32768
    ds_read_b64_tr_b16 v[94:95], v29 offset:34816
    s_sub_u32 s53, s53, 1
    s_waitcnt lgkmcnt(8)
    v_readfirstlane_b32 s54, v5
    s_cselect_b32 s54, 64, s54
    s_cmp_lt_i32 s54, 42
    s_cbranch_scc1 Ls_23

    s_waitcnt lgkmcnt(6)
    v_mfma_f32_16x16x32_bf16 v[112:115], v[80:83], v[64:67], v[112:115]
    s_waitcnt lgkmcnt(4)
    v_mfma_f32_16x16x32_bf16 v[116:119], v[84:87], v[64:67], v[116:119]
    s_waitcnt lgkmcnt(2)
    v_mfma_f32_16x16x32_bf16 v[120:123], v[88:91], v[64:67], v[120:123]
    s_waitcnt lgkmcnt(0)
    v_mfma_f32_16x16x32_bf16 v[124:127], v[92:95], v[64:67], v[124:127]
    s_nop 3
    v_mov_b32_dpp v112, v116 quad_perm:[0,1,2,3] row_mask:0xf bank_mask:0x2
    v_mov_b32_dpp v113, v117 quad_perm:[0,1,2,3] row_mask:0xf bank_mask:0x2
    v_mov_b32_dpp v114, v118 quad_perm:[0,1,2,3] row_mask:0xf bank_mask:0x2
    v_mov_b32_dpp v115, v119 quad_perm:[0,1,2,3] row_mask:0xf bank_mask:0x2
    v_mov_b32_dpp v112, v120 quad_perm:[0,1,2,3] row_mask:0xf bank_mask:0x4
    v_mov_b32_dpp v113, v121 quad_perm:[0,1,2,3] row_mask:0xf bank_mask:0x4
    v_mov_b32_dpp v114, v122 quad_perm:[0,1,2,3] row_mask:0xf bank_mask:0x4
    v_mov_b32_dpp v115, v123 quad_perm:[0,1,2,3] row_mask:0xf bank_mask:0x4
    v_mov_b32_dpp v112, v124 quad_perm:[0,1,2,3] row_mask:0xf bank_mask:0x8
    v_mov_b32_dpp v113, v125 quad_perm:[0,1,2,3] row_mask:0xf bank_mask:0x8
    v_mov_b32_dpp v114, v126 quad_perm:[0,1,2,3] row_mask:0xf bank_mask:0x8
    v_mov_b32_dpp v115, v127 quad_perm:[0,1,2,3] row_mask:0xf bank_mask:0x8
    v_mov_b32_sdwa v112, s30 dst_sel:BYTE_0 dst_unused:UNUSED_PRESERVE src0_sel:BYTE_0
    v_mov_b32_sdwa v113, s30 dst_sel:BYTE_0 dst_unused:UNUSED_PRESERVE src0_sel:BYTE_0
    v_mov_b32_sdwa v114, s30 dst_sel:BYTE_0 dst_unused:UNUSED_PRESERVE src0_sel:BYTE_0
    v_mov_b32_sdwa v115, s30 dst_sel:BYTE_0 dst_unused:UNUSED_PRESERVE src0_sel:BYTE_0
    s_cmp_eq_u32 s34, 1
    s_cbranch_scc0 Lw_25
    buffer_store_dwordx4 v[112:115], v200, s[44:47], s52 offen
    s_branch Le_26
Lw_25:
    buffer_store_dwordx4 v[112:115], v200, s[44:47], s52 offen sc1
Le_26:

    s_endpgm
L_qdump:
    s_endpgm
S_g0:
    .p2align 12
W_g0:
    s_branch W_r0
L_w2:
    s_sub_u32 s58, s31, 1
    s_mul_i32 s55, s58, 12288
    s_add_u32 s55, s55, 36864

    v_lshrrev_b32 v9, 2, v0
    v_lshlrev_b32 v8, 7, v9
    v_bfe_u32 v9, v0, 3, 2
    v_lshl_add_u32 v8, v9, 5, v8
    v_and_b32 v9, 3, v0
    v_lshl_add_u32 v8, v9, 3, v8

    v_add_u32 v8, s55, v8
    v_xor_b32 v9, 32, v8
    v_xor_b32 v10, 64, v8
    v_xor_b32 v11, 96, v8
    v_and_b32 v13, 3, v1
    v_mul_u32_u24 v13, 18, v13
    v_lshrrev_b32 v12, 3, v1
    v_add_u32 v13, v13, v12
    v_mul_u32_u24 v13, 30720, v13
    v_lshl_add_u32 v12, v2, 4, v13
    v_and_b32 v13, 4, v1
    v_lshl_add_u32 v12, v13, 4, v12

    v_and_b32 v3, 3, v1
    v_lshlrev_b32 v3, 4, v3
    v_lshl_add_u32 v3, v2, 7, v3
    v_and_b32 v4, 12, v1

    v_lshl_add_u32 v3, v4, 7, v3
    s_and_b32 s48, s2, 7
    s_lshl_b32 s48, s48, 15
    s_bfe_u32 s49, s2, 0x10003
    s_mul_i32 s49, s49, 3
    s_add_u32 s49, s49, s58
    s_mul_i32 s49, s49, 1536
    s_add_u32 s48, s48, s49
    s_add_u32 s48, s48, 655360
    s_add_u32 s50, s48, 9216
    s_mul_i32 s52, s29, 61440
    s_lshl4_add_u32 s49, s58, s28
    s_mul_i32 s49, s49, 384
    s_add_u32 s52, s52, s49
    s_add_u32 s52, s52, 4206592
    s_mul_i32 s49, s58, 3
    s_add_u32 s49, s49, 45
    s_mov_b32 s55, 32768
    s_mov_b32 s56, 0x0fff0fff
    s_mov_b32 s57, s56

Ls_27:
    ds_read_b32 v5, v6 offset:64
    s_sub_u32 s53, s53, 1
    s_waitcnt lgkmcnt(0)
    v_readfirstlane_b32 s54, v5
    s_cselect_b32 s54, 64, s54
    s_cmp_lt_i32 s54, 47
    s_cbranch_scc1 Ls_27

    s_mov_b64 exec, s[56:57]
    buffer_load_dwordx4 v[64:67], v3, s[44:47], s48 offen offset:0
    buffer_load_dwordx4 v[68:71], v3, s[44:47], s48 offen offset:64
    buffer_load_dwordx4 v[72:75], v3, s[44:47], s50 offen offset:0
    buffer_load_dwordx4 v[76:79], v3, s[44:47], s50 offen offset:64
    s_mov_b64 exec, -1
Ls_29:
    ds_read_b32 v5, v6 offset:64
    s_sub_u32 s53, s53, 1
    s_waitcnt lgkmcnt(0)
    v_readfirstlane_b32 s54, v5
    s_cselect_b32 s54, 64, s54
    s_cmp_lt_i32 s54, s49
    s_cbranch_scc1 Ls_29

    ds_read_b64_tr_b16 v[16:17], v8 offset:0
    ds_read_b64_tr_b16 v[18:19], v8 offset:2048
    ds_read_b64_tr_b16 v[20:21], v9 offset:0
    ds_read_b64_tr_b16 v[22:23], v9 offset:2048
    ds_read_b64_tr_b16 v[24:25], v10 offset:0
    ds_read_b64_tr_b16 v[26:27], v10 offset:2048
    ds_read_b64_tr_b16 v[28:29], v11 offset:0
    ds_read_b64_tr_b16 v[30:31], v11 offset:2048
    ds_read_b64_tr_b16 v[32:33], v8 offset:4096
    ds_read_b64_tr_b16 v[34:35], v8 offset:6144
    ds_read_b64_tr_b16 v[36:37], v9 offset:4096
    ds_read_b64_tr_b16 v[38:39], v9 offset:6144
    ds_read_b64_tr_b16 v[40:41], v10 offset:4096
    ds_read_b64_tr_b16 v[42:43], v10 offset:6144
    ds_read_b64_tr_b16 v[44:45], v11 offset:4096
    ds_read_b64_tr_b16 v[46:47], v11 offset:6144
    ds_read_b64_tr_b16 v[48:49], v8 offset:8192
    ds_read_b64_tr_b16 v[50:51], v8 offset:10240
    ds_read_b64_tr_b16 v[52:53], v9 offset:8192
    ds_read_b64_tr_b16 v[54:55], v9 offset:10240
    ds_read_b64_tr_b16 v[56:57], v10 offset:8192
    ds_read_b64_tr_b16 v[58:59], v10 offset:10240
    ds_read_b64_tr_b16 v[60:61], v11 offset:8192
    ds_read_b64_tr_b16 v[62:63], v11 offset:10240
    s_mov_b64 exec, s[56:57]
L_hc:
    s_waitcnt vmcnt(0)
    v_bitop3_b32 v80, v64, v65, s30 bitop3:0x7e
    v_bitop3_b32 v81, v66, v67, s30 bitop3:0x7e
    v_bitop3_b32 v82, v68, v69, s30 bitop3:0x7e
    v_bitop3_b32 v83, v70, v71, s30 bitop3:0x7e
    v_bitop3_b32 v84, v72, v73, s30 bitop3:0x7e
    v_bitop3_b32 v85, v74, v75, s30 bitop3:0x7e
    v_bitop3_b32 v86, v76, v77, s30 bitop3:0x7e
    v_bitop3_b32 v87, v78, v79, s30 bitop3:0x7e
    v_or3_b32 v80, v80, v81, v82
    v_or3_b32 v83, v83, v84, v85
    v_or3_b32 v80, v80, v86, v87
    v_or_b32 v80, v80, v83
    v_cmp_ne_u32_sdwa vcc, v80, 0 src0_sel:BYTE_0 src1_sel:DWORD
    s_cbranch_vccz L_hg
    s_sub_u32 s55, s55, 1
    s_cbranch_scc1 L_hg
    v_or_b32_dpp v80, v80, v80 quad_perm:[1,0,3,2] row_mask:0xf bank_mask:0xf
    s_nop 1
    v_or_b32_dpp v80, v80, v80 quad_perm:[2,3,0,1] row_mask:0xf bank_mask:0xf
    v_cmp_ne_u32_sdwa vcc, v80, 0 src0_sel:BYTE_0 src1_sel:DWORD
    s_mov_b64 exec, vcc

    buffer_load_dwordx4 v[64:67], v3, s[44:47], s48 offen offset:0 sc1
    buffer_load_dwordx4 v[68:71], v3, s[44:47], s48 offen offset:64 sc1
    buffer_load_dwordx4 v[72:75], v3, s[44:47], s50 offen offset:0 sc1
    buffer_load_dwordx4 v[76:79], v3, s[44:47], s50 offen offset:64 sc1
    s_branch L_hc
L_hg:
    s_mov_b64 exec, -1

    v_pk_add_f32 v[64:65], v[64:65], v[72:73]
    v_pk_add_f32 v[66:67], v[66:67], v[74:75]
    v_pk_add_f32 v[68:69], v[68:69], v[76:77]
    v_pk_add_f32 v[70:71], v[70:71], v[78:79]
    v_cvt_pk_bf16_f32 v80, v64, v65
    v_cvt_pk_bf16_f32 v81, v66, v67
    v_cvt_pk_bf16_f32 v82, v68, v69
    v_cvt_pk_bf16_f32 v83, v70, v71
    v_pk_max_i16 v80, v80, 0
    v_pk_max_i16 v81, v81, 0
    v_pk_max_i16 v82, v82, 0
    v_pk_max_i16 v83, v83, 0
    s_waitcnt lgkmcnt(0)
    v_mov_b32_dpp v84, v80 row_ror:4 row_mask:0xf bank_mask:0xf
    v_mov_b32_dpp v85, v81 row_ror:4 row_mask:0xf bank_mask:0xf
    v_mov_b32_dpp v86, v82 row_ror:4 row_mask:0xf bank_mask:0xf
    v_mov_b32_dpp v87, v83 row_ror:4 row_mask:0xf bank_mask:0xf
    v_mfma_f32_16x16x32_bf16 v[96:99], v[16:19], v[80:83], 0
    v_mfma_f32_16x16x32_bf16 v[100:103], v[36:39], v[80:83], 0
    v_mfma_f32_16x16x32_bf16 v[104:107], v[56:59], v[80:83], 0
    v_mfma_f32_16x16x32_bf16 v[108:111], v[60:63], v[84:87], 0
    v_mov_b32_dpp v88, v80 row_ror:8 row_mask:0xf bank_mask:0xf
    v_mov_b32_dpp v89, v81 row_ror:8 row_mask:0xf bank_mask:0xf
    v_mfma_f32_16x16x32_bf16 v[100:103], v[20:23], v[84:87], v[100:103]
    v_mov_b32_dpp v90, v82 row_ror:8 row_mask:0xf bank_mask:0xf
    v_mov_b32_dpp v91, v83 row_ror:8 row_mask:0xf bank_mask:0xf
    v_mfma_f32_16x16x32_bf16 v[104:107], v[40:43], v[84:87], v[104:107]
    s_nop 0
    v_mfma_f32_16x16x32_bf16 v[96:99], v[48:51], v[88:91], v[96:99]
    v_mov_b32_dpp v92, v80 row_ror:12 row_mask:0xf bank_mask:0xf
    v_mov_b32_dpp v93, v81 row_ror:12 row_mask:0xf bank_mask:0xf
    v_mfma_f32_16x16x32_bf16 v[108:111], v[44:47], v[88:91], v[108:111]
    v_mov_b32_dpp v94, v82 row_ror:12 row_mask:0xf bank_mask:0xf
    v_mov_b32_dpp v95, v83 row_ror:12 row_mask:0xf bank_mask:0xf
    v_mfma_f32_16x16x32_bf16 v[104:107], v[24:27], v[88:91], v[104:107]
    s_nop 0
    v_mfma_f32_16x16x32_bf16 v[100:103], v[52:55], v[92:95], v[100:103]
    v_mfma_f32_16x16x32_bf16 v[96:99], v[32:35], v[92:95], v[96:99]
    v_mfma_f32_16x16x32_bf16 v[108:111], v[28:31], v[92:95], v[108:111]
    s_nop 6
    v_mov_b32_dpp v96, v100 quad_perm:[0,1,2,3] row_mask:0xf bank_mask:0x2
    v_mov_b32_dpp v97, v101 quad_perm:[0,1,2,3] row_mask:0xf bank_mask:0x2
    v_mov_b32_dpp v98, v102 quad_perm:[0,1,2,3] row_mask:0xf bank_mask:0x2
    v_mov_b32_dpp v99, v103 quad_perm:[0,1,2,3] row_mask:0xf bank_mask:0x2
    v_mov_b32_dpp v96, v104 quad_perm:[0,1,2,3] row_mask:0xf bank_mask:0x4
    v_mov_b32_dpp v97, v105 quad_perm:[0,1,2,3] row_mask:0xf bank_mask:0x4
    v_mov_b32_dpp v98, v106 quad_perm:[0,1,2,3] row_mask:0xf bank_mask:0x4
    v_mov_b32_dpp v99, v107 quad_perm:[0,1,2,3] row_mask:0xf bank_mask:0x4
    v_mov_b32_dpp v96, v108 quad_perm:[0,1,2,3] row_mask:0xf bank_mask:0x8
    v_mov_b32_dpp v97, v109 quad_perm:[0,1,2,3] row_mask:0xf bank_mask:0x8
    v_mov_b32_dpp v98, v110 quad_perm:[0,1,2,3] row_mask:0xf bank_mask:0x8
    v_mov_b32_dpp v99, v111 quad_perm:[0,1,2,3] row_mask:0xf bank_mask:0x8
    v_mov_b32_sdwa v96, s30 dst_sel:BYTE_0 dst_unused:UNUSED_PRESERVE src0_sel:BYTE_0
    v_mov_b32_sdwa v97, s30 dst_sel:BYTE_0 dst_unused:UNUSED_PRESERVE src0_sel:BYTE_0
    v_mov_b32_sdwa v98, s30 dst_sel:BYTE_0 dst_unused:UNUSED_PRESERVE src0_sel:BYTE_0
    v_mov_b32_sdwa v99, s30 dst_sel:BYTE_0 dst_unused:UNUSED_PRESERVE src0_sel:BYTE_0
    buffer_store_dwordx4 v[96:99], v12, s[44:47], s52 offen sc1
    s_waitcnt vmcnt(0)
    s_mov_b64 exec, 1

    ds_add_u32 v6, v7 offset:16

    s_mov_b64 exec, -1

    s_endpgm
S_r0:
W_r0:
    s_branch L_KV
L_red:
    s_mov_b32 s32, s4
    s_mov_b32 s33, s5
    s_mov_b32 s34, 4608
    s_mov_b32 s35, 0x20000
    s_mov_b32 s40, s20
    s_mov_b32 s41, s21
    s_mov_b32 s42, 1152
    s_mov_b32 s43, 0x20000
    s_mov_b32 s36, s22
    s_mov_b32 s37, s23
    s_mov_b32 s38, 4608
    s_mov_b32 s39, 0x20000
    s_and_b32 s48, s2, 7
    s_mul_i32 s48, s48, 18
    s_lshr_b32 s49, s2, 3
    s_add_u32 s48, s48, s49

    s_mul_i32 s49, s48, 1821
    s_lshr_b32 s49, s49, 16
    s_mul_i32 s49, s49, 1152
    v_lshlrev_b32 v3, 4, v0
    v_lshlrev_b32 v4, 2, v0
    v_mov_b32 v12, 0
    v_mov_b32 v20, 0
    buffer_load_dwordx4 v[8:11], v3, s[32:35], s49 offen
    buffer_load_dwordx4 v[16:19], v3, s[40:43], 0 offen
    s_mov_b64 exec, 0xffffffff
    s_mov_b32 exec_hi, 0
    buffer_load_dword v12, v4, s[32:35], s49 offen offset:1024
    buffer_load_dword v20, v4, s[40:43], 0 offen offset:1024
    s_mov_b64 exec, -1
    s_lshr_b32 s50, s48, 1
    s_mul_i32 s50, s50, 30720
    s_bfe_u32 s51, s48, 0x10000
    s_lshl_b32 s51, s51, 6
    s_add_u32 s50, s50, s51
    s_add_u32 s50, s50, 4194304

    s_add_u32 s51, s50, 6144
    s_add_u32 s52, s50, 12288
    s_add_u32 s84, s50, 18432
    s_add_u32 s85, s50, 24576
    v_lshrrev_b32 v28, 2, v0
    v_mul_u32_u24 v28, 384, v28
    v_and_b32 v29, 3, v0
    v_lshl_add_u32 v28, v29, 4, v28

    v_mov_b32 v5, 0
    s_mov_b32 s59, 0xffff0000
    s_waitcnt vmcnt(0)

    v_lshlrev_b32 v24, 16, v8
    v_and_b32 v25, s59, v8
    v_lshlrev_b32 v26, 16, v16
    v_and_b32 v27, s59, v16
    v_mul_f32 v24, v24, v26
    v_mul_f32 v25, v25, v27
    v_cvt_pk_bf16_f32 v24, v24, v25
    v_lshlrev_b32 v25, 16, v24
    v_and_b32 v24, s59, v24
    v_add_f32 v5, v5, v25
    v_add_f32 v5, v5, v24

    v_lshlrev_b32 v24, 16, v9
    v_and_b32 v25, s59, v9
    v_lshlrev_b32 v26, 16, v17
    v_and_b32 v27, s59, v17
    v_mul_f32 v24, v24, v26
    v_mul_f32 v25, v25, v27
    v_cvt_pk_bf16_f32 v24, v24, v25
    v_lshlrev_b32 v25, 16, v24
    v_and_b32 v24, s59, v24
    v_add_f32 v5, v5, v25
    v_add_f32 v5, v5, v24

    v_lshlrev_b32 v24, 16, v10
    v_and_b32 v25, s59, v10
    v_lshlrev_b32 v26, 16, v18
    v_and_b32 v27, s59, v18
    v_mul_f32 v24, v24, v26
    v_mul_f32 v25, v25, v27
    v_cvt_pk_bf16_f32 v24, v24, v25
    v_lshlrev_b32 v25, 16, v24
    v_and_b32 v24, s59, v24
    v_add_f32 v5, v5, v25
    v_add_f32 v5, v5, v24

    v_lshlrev_b32 v24, 16, v11
    v_and_b32 v25, s59, v11
    v_lshlrev_b32 v26, 16, v19
    v_and_b32 v27, s59, v19
    v_mul_f32 v24, v24, v26
    v_mul_f32 v25, v25, v27
    v_cvt_pk_bf16_f32 v24, v24, v25
    v_lshlrev_b32 v25, 16, v24
    v_and_b32 v24, s59, v24
    v_add_f32 v5, v5, v25
    v_add_f32 v5, v5, v24

    v_lshlrev_b32 v24, 16, v12
    v_and_b32 v25, s59, v12
    v_lshlrev_b32 v26, 16, v20
    v_and_b32 v27, s59, v20
    v_mul_f32 v24, v24, v26
    v_mul_f32 v25, v25, v27
    v_cvt_pk_bf16_f32 v24, v24, v25
    v_lshlrev_b32 v25, 16, v24
    v_and_b32 v24, s59, v24
    v_add_f32 v5, v5, v25
    v_add_f32 v5, v5, v24

    s_nop 1
    v_add_f32_dpp v5, v5, v5 row_ror:1 row_mask:0xf bank_mask:0xf
    s_nop 1
    v_add_f32_dpp v5, v5, v5 row_ror:2 row_mask:0xf bank_mask:0xf
    s_nop 1
    v_add_f32_dpp v5, v5, v5 row_ror:4 row_mask:0xf bank_mask:0xf
    s_nop 1
    v_add_f32_dpp v5, v5, v5 row_ror:8 row_mask:0xf bank_mask:0xf
    v_mov_b32 v4, v5
    s_nop 1
    v_permlane16_swap_b32 v5, v4
    v_add_f32 v5, v5, v4
    v_mov_b32 v4, v5
    s_nop 1
    v_permlane32_swap_b32 v5, v4
    v_add_f32 v5, v5, v4

    v_cvt_pk_bf16_f32 v5, v5, v5
    v_and_b32 v5, s59, v5
    v_mul_f32 v5, 0xbfb8aa3b, v5
    v_exp_f32 v5, v5
    s_nop 0
    v_add_f32 v5, 1.0, v5
    v_rcp_f32 v5, v5
    s_nop 0
    v_cvt_pk_bf16_f32 v5, v5, v5
    v_and_b32 v5, s59, v5
    v_sub_f32 v4, 1.0, v5
    v_cvt_pk_bf16_f32 v4, v4, v4
    v_and_b32 v4, s59, v4
    v_and_b32 v7, 3, v0
    v_lshl_add_u32 v7, v7, 2, v2
    v_lshlrev_b32 v7, 1, v7
    s_lshl_b32 s55, s48, 5
    s_mov_b32 s53, 262144

    s_mov_b32 exec_lo, 0x000f000f
    s_mov_b32 exec_hi, 0x000f000f
    buffer_store_short v5, v7, s[36:39], s55 offen sc1
    s_mov_b64 exec, -1

S_r1:
Ls_39:
    ds_read_b32 v60, v6 offset:16
    s_sub_u32 s53, s53, 1
    s_waitcnt lgkmcnt(0)
    v_readfirstlane_b32 s54, v60
    s_cselect_b32 s54, 64, s54
    s_cmp_lt_i32 s54, 3
    s_cbranch_scc1 Ls_39

    s_mov_b32 s53, 32768
    s_mov_b64 s[74:75], -1
    s_mov_b64 s[76:77], -1
    s_mov_b64 s[78:79], -1
    s_mov_b64 s[80:81], -1
    s_mov_b64 s[82:83], -1
L_rpoll:
    s_mov_b64 exec, s[74:75]
    buffer_load_dwordx4 v[8:11], v28, s[44:47], s50 offen sc1
Lrl_41:
    s_mov_b64 exec, s[76:77]
    buffer_load_dwordx4 v[12:15], v28, s[44:47], s51 offen sc1
Lrl_42:
    s_mov_b64 exec, s[78:79]
    buffer_load_dwordx4 v[16:19], v28, s[44:47], s52 offen sc1
Lrl_43:
    s_mov_b64 exec, s[80:81]
    buffer_load_dwordx4 v[20:23], v28, s[44:47], s84 offen sc1
Lrl_44:
    s_mov_b64 exec, s[82:83]
    buffer_load_dwordx4 v[24:27], v28, s[44:47], s85 offen sc1
Lrl_45:
    s_mov_b64 exec, -1
    s_waitcnt vmcnt(0)
    v_bitop3_b32 v60, v8, v9, s30 bitop3:0x7e
    v_bitop3_b32 v61, v10, v11, s30 bitop3:0x7e

    v_bitop3_b32 v62, v12, v13, s30 bitop3:0x7e
    v_bitop3_b32 v63, v14, v15, s30 bitop3:0x7e

    v_bitop3_b32 v64, v16, v17, s30 bitop3:0x7e
    v_bitop3_b32 v65, v18, v19, s30 bitop3:0x7e

    v_bitop3_b32 v66, v20, v21, s30 bitop3:0x7e
    v_bitop3_b32 v67, v22, v23, s30 bitop3:0x7e

    v_bitop3_b32 v68, v24, v25, s30 bitop3:0x7e
    v_bitop3_b32 v69, v26, v27, s30 bitop3:0x7e

    v_or_b32 v60, v60, v61
    v_or_b32 v62, v62, v63
    v_or_b32 v64, v64, v65
    v_or_b32 v66, v66, v67
    v_or_b32 v68, v68, v69
    v_or3_b32 v70, v60, v62, v64
    v_or3_b32 v70, v70, v66, v68
    v_cmp_ne_u32_sdwa vcc, v70, 0 src0_sel:BYTE_0 src1_sel:DWORD
    s_cbranch_vccz L_rgot

    v_or_b32_dpp v60, v60, v60 quad_perm:[1,0,3,2] row_mask:0xf bank_mask:0xf
    v_or_b32_dpp v62, v62, v62 quad_perm:[1,0,3,2] row_mask:0xf bank_mask:0xf
    v_or_b32_dpp v64, v64, v64 quad_perm:[1,0,3,2] row_mask:0xf bank_mask:0xf
    v_or_b32_dpp v66, v66, v66 quad_perm:[1,0,3,2] row_mask:0xf bank_mask:0xf
    v_or_b32_dpp v68, v68, v68 quad_perm:[1,0,3,2] row_mask:0xf bank_mask:0xf
    v_cmp_ne_u32_sdwa s[74:75], v60, 0 src0_sel:BYTE_0 src1_sel:DWORD
    v_cmp_ne_u32_sdwa s[76:77], v62, 0 src0_sel:BYTE_0 src1_sel:DWORD
    v_cmp_ne_u32_sdwa s[78:79], v64, 0 src0_sel:BYTE_0 src1_sel:DWORD
    v_cmp_ne_u32_sdwa s[80:81], v66, 0 src0_sel:BYTE_0 src1_sel:DWORD
    v_cmp_ne_u32_sdwa s[82:83], v68, 0 src0_sel:BYTE_0 src1_sel:DWORD
    s_sub_u32 s53, s53, 1
    s_cbranch_scc0 L_rpoll
L_rgot:

    v_pk_add_f32 v[16:17], v[16:17], v[20:21]
    v_pk_add_f32 v[18:19], v[18:19], v[22:23]

    v_pk_add_f32 v[8:9], v[8:9], v[12:13]
    v_pk_add_f32 v[10:11], v[10:11], v[14:15]
    v_pk_add_f32 v[16:17], v[16:17], v[24:25]
    v_pk_add_f32 v[18:19], v[18:19], v[26:27]

    s_nop 0
    v_permlane32_swap_b32 v8, v16
    v_permlane32_swap_b32 v9, v17
    v_permlane32_swap_b32 v10, v18
    v_permlane32_swap_b32 v11, v19
    v_pk_add_f32 v[8:9], v[8:9], v[16:17]
    v_pk_add_f32 v[10:11], v[10:11], v[18:19]
    s_nop 0
    v_permlane16_swap_b32 v8, v9
    v_permlane16_swap_b32 v10, v11
    v_add_f32 v8, v8, v9
    v_add_f32 v10, v10, v11
    s_nop 0
    v_add_f32_dpp v8, v8, v8 row_ror:4 row_mask:0xf bank_mask:0xf
    v_add_f32_dpp v10, v10, v10 row_ror:4 row_mask:0xf bank_mask:0xf
    s_nop 0
    v_add_f32_dpp v8, v8, v8 row_ror:8 row_mask:0xf bank_mask:0xf
    v_add_f32_dpp v10, v10, v10 row_ror:8 row_mask:0xf bank_mask:0xf

    s_nop 1
    v_permlane32_swap_b32 v8, v10
    v_cvt_pk_bf16_f32 v8, v8, v10
    v_and_b32 v10, s59, v8
    v_lshlrev_b32 v8, 16, v8
    v_mul_f32 v8, v5, v8
    v_mul_f32 v10, v4, v10
    v_cvt_pk_bf16_f32 v8, v8, v10
    v_and_b32 v10, s59, v8
    v_lshlrev_b32 v8, 16, v8
    v_add_f32 v8, v8, v10
    s_mov_b32 exec_lo, 0x000f000f
    s_mov_b32 exec_hi, 0x000f000f
    v_cvt_pk_bf16_f32 v8, v8, v8

    buffer_store_short v8, v7, s[36:39], s55 offen
    s_cmp_lg_u32 s48, 0
    s_cbranch_scc1 L_rend

    s_mov_b64 exec, 0xff
    v_mov_b32 v48, s30
    v_mov_b32 v49, s30
    v_mov_b32 v50, s30
    v_mov_b32 v51, s30
    buffer_store_dwordx4 v[48:51], v3, s[44:47], 0 offen

L_rend:
    s_endpgm
S_lp:
W_lp:
    s_branch L_KV
L_lP:
    s_mov_b32 s36, s12
    s_mov_b32 s37, s13
    s_mov_b32 s38, 4718592
    s_mov_b32 s39, 0x20000
    s_sub_u32 s48, s29, 9
    s_and_b32 s49, s48, 1
    s_lshr_b32 s48, s48, 1
    s_lshl_b32 s50, s28, 1
    s_add_u32 s49, s49, s50
    s_mul_i32 s49, s49, 147456
    s_mulk_i32 s48, 384
    s_add_u32 s49, s49, s48
    s_mov_b32 s41, 36864

Ls_46:
    ds_read_b32 v4, v6 offset:0
    s_sub_u32 s53, s53, 1
    s_waitcnt lgkmcnt(0)
    v_readfirstlane_b32 s54, v4
    s_cselect_b32 s54, 64, s54
    s_cmp_lt_i32 s54, 5
    s_cbranch_scc1 Ls_46

    s_waitcnt vmcnt(20)
    buffer_load_dwordx4 v16, s[36:39], s49 offen offset:0 nt lds
    buffer_load_dwordx4 v17, s[36:39], s49 offen offset:1024 nt lds
    buffer_load_dwordx4 v18, s[36:39], s49 offen offset:2048 nt lds
    buffer_load_dwordx4 v19, s[36:39], s49 offen offset:3072 nt lds
    s_add_u32 m0, m0, s40
    s_add_u32 s49, s49, s41
    s_waitcnt vmcnt(20)
    v_max_i32 v14, 29, v14
    ds_write_b32 v15, v14
    buffer_load_dwordx4 v16, s[36:39], s49 offen offset:0 nt lds
    buffer_load_dwordx4 v17, s[36:39], s49 offen offset:1024 nt lds
    buffer_load_dwordx4 v18, s[36:39], s49 offen offset:2048 nt lds
    buffer_load_dwordx4 v19, s[36:39], s49 offen offset:3072 nt lds
    s_add_u32 m0, m0, s40
    s_add_u32 s49, s49, s41
    s_waitcnt vmcnt(20)
    buffer_load_dwordx4 v16, s[36:39], s49 offen offset:0 nt lds
    buffer_load_dwordx4 v17, s[36:39], s49 offen offset:1024 nt lds
    buffer_load_dwordx4 v18, s[36:39], s49 offen offset:2048 nt lds
    buffer_load_dwordx4 v19, s[36:39], s49 offen offset:3072 nt lds
    s_add_u32 m0, m0, s40
    s_add_u32 s49, s49, s41
    s_waitcnt vmcnt(20)
    v_max_i32 v14, 31, v14
    ds_write_b32 v15, v14
    buffer_load_dwordx4 v16, s[36:39], s49 offen offset:0 nt lds
    buffer_load_dwordx4 v17, s[36:39], s49 offen offset:1024 nt lds
    buffer_load_dwordx4 v18, s[36:39], s49 offen offset:2048 nt lds
    buffer_load_dwordx4 v19, s[36:39], s49 offen offset:3072 nt lds
    s_add_u32 m0, m0, s40
    s_sub_u32 s49, s49, 110464
    s_waitcnt vmcnt(20)
    buffer_load_dwordx4 v16, s[36:39], s49 offen offset:0 nt lds
    buffer_load_dwordx4 v17, s[36:39], s49 offen offset:1024 nt lds
    buffer_load_dwordx4 v18, s[36:39], s49 offen offset:2048 nt lds
    buffer_load_dwordx4 v19, s[36:39], s49 offen offset:3072 nt lds
    s_add_u32 m0, m0, s40
    s_add_u32 s49, s49, s41
    s_waitcnt vmcnt(20)
    v_max_i32 v14, 33, v14
    ds_write_b32 v15, v14
    buffer_load_dwordx4 v16, s[36:39], s49 offen offset:0 nt lds
    buffer_load_dwordx4 v17, s[36:39], s49 offen offset:1024 nt lds
    buffer_load_dwordx4 v18, s[36:39], s49 offen offset:2048 nt lds
    buffer_load_dwordx4 v19, s[36:39], s49 offen offset:3072 nt lds
    s_add_u32 m0, m0, s40
    s_add_u32 s49, s49, s41
    s_waitcnt vmcnt(20)
    v_max_i32 v14, 34, v14
    ds_write_b32 v15, v14
    buffer_load_dwordx4 v16, s[36:39], s49 offen offset:0 nt lds
    buffer_load_dwordx4 v17, s[36:39], s49 offen offset:1024 nt lds
    buffer_load_dwordx4 v18, s[36:39], s49 offen offset:2048 nt lds
    buffer_load_dwordx4 v19, s[36:39], s49 offen offset:3072 nt lds
    s_add_u32 m0, m0, s40
    s_add_u32 s49, s49, s41
    s_waitcnt vmcnt(20)
    v_max_i32 v14, 35, v14
    ds_write_b32 v15, v14
    buffer_load_dwordx4 v16, s[36:39], s49 offen offset:0 nt lds
    buffer_load_dwordx4 v17, s[36:39], s49 offen offset:1024 nt lds
    buffer_load_dwordx4 v18, s[36:39], s49 offen offset:2048 nt lds
    buffer_load_dwordx4 v19, s[36:39], s49 offen offset:3072 nt lds
    s_add_u32 m0, m0, s40
    s_sub_u32 s49, s49, 110464
    s_waitcnt vmcnt(20)
    v_max_i32 v14, 36, v14
    ds_write_b32 v15, v14
    buffer_load_dwordx4 v16, s[36:39], s49 offen offset:0 nt lds
    buffer_load_dwordx4 v17, s[36:39], s49 offen offset:1024 nt lds
    buffer_load_dwordx4 v18, s[36:39], s49 offen offset:2048 nt lds
    buffer_load_dwordx4 v19, s[36:39], s49 offen offset:3072 nt lds
    s_add_u32 m0, m0, s40
    s_add_u32 s49, s49, s41
    s_waitcnt vmcnt(20)
    v_max_i32 v14, 37, v14
    ds_write_b32 v15, v14
    buffer_load_dwordx4 v16, s[36:39], s49 offen offset:0 nt lds
    buffer_load_dwordx4 v17, s[36:39], s49 offen offset:1024 nt lds
    buffer_load_dwordx4 v18, s[36:39], s49 offen offset:2048 nt lds
    buffer_load_dwordx4 v19, s[36:39], s49 offen offset:3072 nt lds
    s_add_u32 m0, m0, s40
    s_add_u32 s49, s49, s41
    s_waitcnt vmcnt(20)
    v_max_i32 v14, 38, v14
    ds_write_b32 v15, v14
    buffer_load_dwordx4 v16, s[36:39], s49 offen offset:0 nt lds
    buffer_load_dwordx4 v17, s[36:39], s49 offen offset:1024 nt lds
    buffer_load_dwordx4 v18, s[36:39], s49 offen offset:2048 nt lds
    buffer_load_dwordx4 v19, s[36:39], s49 offen offset:3072 nt lds
    s_add_u32 m0, m0, s40
    s_add_u32 s49, s49, s41
    s_waitcnt vmcnt(20)
    v_max_i32 v14, 39, v14
    ds_write_b32 v15, v14
    buffer_load_dwordx4 v16, s[36:39], s49 offen offset:0 nt lds
    buffer_load_dwordx4 v17, s[36:39], s49 offen offset:1024 nt lds
    buffer_load_dwordx4 v18, s[36:39], s49 offen offset:2048 nt lds
    buffer_load_dwordx4 v19, s[36:39], s49 offen offset:3072 nt lds
    s_waitcnt vmcnt(20)
    v_max_i32 v14, 40, v14
    ds_write_b32 v15, v14
    s_waitcnt vmcnt(16)
    v_max_i32 v14, 41, v14
    ds_write_b32 v15, v14
    s_waitcnt vmcnt(12)
    v_max_i32 v14, 42, v14
    ds_write_b32 v15, v14
    s_waitcnt vmcnt(8)
    v_max_i32 v14, 43, v14
    ds_write_b32 v15, v14
    s_waitcnt vmcnt(4)
    v_max_i32 v14, 44, v14
    ds_write_b32 v15, v14
    s_waitcnt vmcnt(0)
    v_max_i32 v14, 45, v14
    ds_write_b32 v15, v14
    s_endpgm
L_lspare:
    s_waitcnt vmcnt(16)
    v_max_i32 v14, 29, v14
    ds_write_b32 v15, v14
    s_waitcnt vmcnt(8)
    v_max_i32 v14, 31, v14
    ds_write_b32 v15, v14
    s_waitcnt vmcnt(0)
    v_max_i32 v14, 33, v14
    ds_write_b32 v15, v14
    s_endpgm
S_k0:
    .p2align 12
L_KV:
    s_sub_u32 s31, s3, 2
    s_lshl_b32 s49, s31, 14
    s_add_u32 s49, s49, 18432
    v_xor_b32 v8, v1, v2
    v_lshlrev_b32 v8, 4, v8
    v_lshl_add_u32 v8, v1, 8, v8
    v_add_u32 v8, s49, v8
    v_xor_b32 v9, 64, v8
    v_xor_b32 v10, 0x80, v8
    v_xor_b32 v11, 0xc0, v8
    v_and_b32 v12, 1, v1
    v_lshlrev_b32 v3, 8, v12
    v_lshl_add_u32 v3, v2, 4, v3
    v_add_u32 v3, 154624, v3
    s_lshl_b32 s48, s31, 2
    s_add_u32 s48, s48, 5
    s_mov_b32 s53, 262144

    s_mov_b32 s44, s26
    s_mov_b32 s45, s27
    s_mov_b32 s46, 268435456
    s_mov_b32 s47, 0x20000
    v_lshlrev_b32 v13, 5, v2
    v_lshl_add_u32 v13, v12, 4, v13
    v_add_u32 v13, 155136, v13
    s_lshl_b32 s55, s31, 8
    v_add_u32 v14, s55, v13
    v_lshlrev_b32 v15, 5, v12
    v_add_u32 v15, 157184, v15
    s_lshl_b32 s55, s31, 2
    v_add_u32 v4, s55, v15
    s_waitcnt lgkmcnt(0)
    s_add_u32 s30, s30, 2654435769

Ls_48:
    ds_read_b32 v5, v6 offset:64
    s_sub_u32 s53, s53, 1
    s_waitcnt lgkmcnt(0)
    v_readfirstlane_b32 s54, v5
    s_cselect_b32 s54, 64, s54
    s_cmp_lt_i32 s54, s48
    s_cbranch_scc1 Ls_48

    ds_read_b128 v[16:19], v8 offset:0
    ds_read_b128 v[20:23], v9 offset:0
    ds_read_b128 v[24:27], v10 offset:0
    ds_read_b128 v[28:31], v11 offset:0
    ds_read_b128 v[32:35], v8 offset:4096
    ds_read_b128 v[36:39], v9 offset:4096
    ds_read_b128 v[40:43], v10 offset:4096
    ds_read_b128 v[44:47], v11 offset:4096
    ds_read_b128 v[48:51], v8 offset:8192
    ds_read_b128 v[52:55], v9 offset:8192
    ds_read_b128 v[56:59], v10 offset:8192
    ds_read_b128 v[60:63], v11 offset:8192
    ds_read_b128 v[64:67], v8 offset:12288
    ds_read_b128 v[68:71], v9 offset:12288
    ds_read_b128 v[72:75], v10 offset:12288
    ds_read_b128 v[76:79], v11 offset:12288
    s_mov_b64 exec, 1
    ds_add_u32 v6, v7 offset:0
    s_mov_b64 exec, -1

    v_lshrrev_b32 v9, 2, v0
    v_lshlrev_b32 v8, 8, v9
    v_and_b32 v9, 7, v9
    v_lshl_add_u32 v8, v9, 5, v8
    v_and_b32 v9, 3, v0
    v_lshl_add_u32 v8, v9, 3, v8
    v_add_u32 v8, 83968, v8
    s_lshl_b32 s55, s31, 6
    v_xor_b32 v8, s55, v8
    v_xor_b32 v9, 32, v8
    v_lshrrev_b32 v10, 2, v1
    v_lshlrev_b32 v10, 6, v10
    v_lshl_add_u32 v10, v2, 4, v10
    v_lshl_add_u32 v10, v12, 13, v10
    v_lshlrev_b32 v11, 4, v1
    s_lshl_b32 s48, s28, 14
    s_lshl_b32 s49, s29, 9
    s_add_u32 s48, s48, s49
    s_lshl_b32 s49, s31, 7
    s_add_u32 s48, s48, s49
    s_add_u32 s48, s48, 327680
    s_lshl_b32 s49, s28, 11
    s_lshl_b32 s50, s29, 7
    s_add_u32 s49, s49, s50
    s_add_u32 s49, s49, 589824
    s_mov_b32 s59, 0xffff0000
    s_mov_b32 s56, 0x3db504f3
    s_mov_b32 s57, 0x3fb8aa3b

    v_not_b32 v120, s30
    v_mov_b32 v121, v120
    v_mov_b32 v122, v120
    v_mov_b32 v123, v120
    s_mov_b32 exec_lo, 0x00330033
    s_mov_b32 exec_hi, 0x00330033
    buffer_store_dwordx4 v[120:123], v10, s[44:47], s48 offen
    s_mov_b64 exec, -1

    s_waitcnt lgkmcnt(0)
S_k1:
Ls_50:
    ds_read_b32 v5, v6 offset:4
    ds_read_b128 v[80:83], v3 offset:0
    ds_read_b128 v[84:87], v3 offset:64
    ds_read_b128 v[88:91], v3 offset:128
    ds_read_b128 v[92:95], v3 offset:192
    s_sub_u32 s53, s53, 1
    s_waitcnt lgkmcnt(4)
    v_readfirstlane_b32 s54, v5
    s_cselect_b32 s54, 64, s54
    s_cmp_lt_i32 s54, 1
    s_cbranch_scc1 Ls_50

    s_mov_b32 s34, s54
    s_waitcnt lgkmcnt(0)
    v_mfma_f32_16x16x32_bf16 v[96:99], v[16:19], v[80:83], 0
    v_mfma_f32_16x16x32_bf16 v[100:103], v[32:35], v[80:83], 0
    v_mfma_f32_16x16x32_bf16 v[104:107], v[48:51], v[80:83], 0
    v_mfma_f32_16x16x32_bf16 v[108:111], v[64:67], v[80:83], 0
    v_mfma_f32_16x16x32_bf16 v[96:99], v[20:23], v[84:87], v[96:99]
    v_mfma_f32_16x16x32_bf16 v[100:103], v[36:39], v[84:87], v[100:103]
    v_mfma_f32_16x16x32_bf16 v[104:107], v[52:55], v[84:87], v[104:107]
    v_mfma_f32_16x16x32_bf16 v[108:111], v[68:71], v[84:87], v[108:111]
    v_mfma_f32_16x16x32_bf16 v[96:99], v[24:27], v[88:91], v[96:99]
    v_mfma_f32_16x16x32_bf16 v[100:103], v[40:43], v[88:91], v[100:103]
    v_mfma_f32_16x16x32_bf16 v[104:107], v[56:59], v[88:91], v[104:107]
    v_mfma_f32_16x16x32_bf16 v[108:111], v[72:75], v[88:91], v[108:111]
    v_mfma_f32_16x16x32_bf16 v[96:99], v[28:31], v[92:95], v[96:99]
    v_mfma_f32_16x16x32_bf16 v[100:103], v[44:47], v[92:95], v[100:103]
    v_mfma_f32_16x16x32_bf16 v[104:107], v[60:63], v[92:95], v[104:107]
    v_mfma_f32_16x16x32_bf16 v[108:111], v[76:79], v[92:95], v[108:111]
    s_nop 4
    v_cvt_pk_bf16_f32 v97, v96, v97
    v_cvt_pk_bf16_f32 v99, v98, v99
    v_cvt_pk_bf16_f32 v101, v100, v101
    v_cvt_pk_bf16_f32 v103, v102, v103
    v_cvt_pk_bf16_f32 v105, v104, v105
    v_cvt_pk_bf16_f32 v107, v106, v107
    v_cvt_pk_bf16_f32 v109, v108, v109
    v_cvt_pk_bf16_f32 v111, v110, v111
    v_lshlrev_b32 v96, 16, v97
    v_and_b32 v97, s59, v97
    v_lshlrev_b32 v98, 16, v99
    v_and_b32 v99, s59, v99
    v_lshlrev_b32 v100, 16, v101
    v_and_b32 v101, s59, v101
    v_lshlrev_b32 v102, 16, v103
    v_and_b32 v103, s59, v103
    v_lshlrev_b32 v104, 16, v105
    v_and_b32 v105, s59, v105
    v_lshlrev_b32 v106, 16, v107
    v_and_b32 v107, s59, v107
    v_lshlrev_b32 v108, 16, v109
    v_and_b32 v109, s59, v109
    v_lshlrev_b32 v110, 16, v111
    v_and_b32 v111, s59, v111
    v_mul_f32 v96, s56, v96
    v_mul_f32 v97, s56, v97
    v_mul_f32 v98, s56, v98
    v_mul_f32 v99, s56, v99
    v_mul_f32 v100, s56, v100
    v_mul_f32 v101, s56, v101
    v_mul_f32 v102, s56, v102
    v_mul_f32 v103, s56, v103
    v_mul_f32 v104, s56, v104
    v_mul_f32 v105, s56, v105
    v_mul_f32 v106, s56, v106
    v_mul_f32 v107, s56, v107
    v_mul_f32 v108, s56, v108
    v_mul_f32 v109, s56, v109
    v_mul_f32 v110, s56, v110
    v_mul_f32 v111, s56, v111
    v_cvt_pk_bf16_f32 v97, v96, v97
    v_cvt_pk_bf16_f32 v99, v98, v99
    v_cvt_pk_bf16_f32 v101, v100, v101
    v_cvt_pk_bf16_f32 v103, v102, v103
    v_cvt_pk_bf16_f32 v105, v104, v105
    v_cvt_pk_bf16_f32 v107, v106, v107
    v_cvt_pk_bf16_f32 v109, v108, v109
    v_cvt_pk_bf16_f32 v111, v110, v111
    v_lshlrev_b32 v96, 16, v97
    v_and_b32 v97, s59, v97
    v_lshlrev_b32 v98, 16, v99
    v_and_b32 v99, s59, v99
    v_lshlrev_b32 v100, 16, v101
    v_and_b32 v101, s59, v101
    v_lshlrev_b32 v102, 16, v103
    v_and_b32 v103, s59, v103
    v_lshlrev_b32 v104, 16, v105
    v_and_b32 v105, s59, v105
    v_lshlrev_b32 v106, 16, v107
    v_and_b32 v107, s59, v107
    v_lshlrev_b32 v108, 16, v109
    v_and_b32 v109, s59, v109
    v_lshlrev_b32 v110, 16, v111
    v_and_b32 v111, s59, v111
    v_max3_f32 v80, v96, v97, v98
    v_max3_f32 v81, v99, v100, v101
    v_max3_f32 v82, v102, v103, v104
    v_max3_f32 v83, v105, v106, v107
    v_max3_f32 v80, v80, v108, v109
    v_max3_f32 v81, v81, v110, v111
    v_max3_f32 v80, v80, v81, v82
    v_max_f32 v80, v80, v83
    v_mov_b32 v81, v80
    s_nop 1
    v_permlane16_swap_b32 v80, v81
    v_max_f32 v80, v80, v81
    v_mov_b32 v81, v80
    s_nop 1
    v_permlane32_swap_b32 v80, v81
    v_max_f32 v80, v80, v81
    v_mul_f32 v80, s57, v80

    v_fma_f32 v96, v96, s57, -v80
    v_fma_f32 v97, v97, s57, -v80
    v_fma_f32 v98, v98, s57, -v80
    v_fma_f32 v99, v99, s57, -v80
    v_fma_f32 v100, v100, s57, -v80
    v_fma_f32 v101, v101, s57, -v80
    v_fma_f32 v102, v102, s57, -v80
    v_fma_f32 v103, v103, s57, -v80
    v_fma_f32 v104, v104, s57, -v80
    v_fma_f32 v105, v105, s57, -v80
    v_fma_f32 v106, v106, s57, -v80
    v_fma_f32 v107, v107, s57, -v80
    v_fma_f32 v108, v108, s57, -v80
    v_fma_f32 v109, v109, s57, -v80
    v_fma_f32 v110, v110, s57, -v80
    v_fma_f32 v111, v111, s57, -v80
    v_exp_f32 v96, v96
    v_exp_f32 v97, v97
    v_exp_f32 v98, v98
    v_exp_f32 v99, v99
    v_exp_f32 v100, v100
    v_exp_f32 v101, v101
    v_exp_f32 v102, v102
    v_exp_f32 v103, v103
    v_exp_f32 v104, v104
    v_exp_f32 v105, v105
    v_exp_f32 v106, v106
    v_exp_f32 v107, v107
    v_exp_f32 v108, v108
    v_exp_f32 v109, v109
    v_exp_f32 v110, v110
    v_exp_f32 v111, v111
    v_cvt_pk_bf16_f32 v112, v96, v97
    v_cvt_pk_bf16_f32 v113, v98, v99
    v_cvt_pk_bf16_f32 v114, v100, v101
    v_cvt_pk_bf16_f32 v115, v102, v103
    v_cvt_pk_bf16_f32 v116, v104, v105
    v_cvt_pk_bf16_f32 v117, v106, v107
    v_cvt_pk_bf16_f32 v118, v108, v109
    v_cvt_pk_bf16_f32 v119, v110, v111
    s_mov_b32 exec_lo, 0x00030003
    s_mov_b32 exec_hi, 0x00030003
    ds_write_b128 v14, v[112:115]
    ds_write_b128 v14, v[116:119] offset:128
    s_mov_b64 exec, -1

    v_add_f32 v96, v96, v104
    v_add_f32 v97, v97, v105
    v_add_f32 v98, v98, v106
    v_add_f32 v99, v99, v107
    v_add_f32 v100, v100, v108
    v_add_f32 v101, v101, v109
    v_add_f32 v102, v102, v110
    v_add_f32 v103, v103, v111
    v_add_f32 v96, v96, v100
    v_add_f32 v97, v97, v101
    v_add_f32 v98, v98, v102
    v_add_f32 v99, v99, v103
    v_add_f32 v96, v96, v98
    v_add_f32 v97, v97, v99
    v_add_f32 v81, v96, v97
    v_mov_b32 v82, v81
    s_nop 1
    v_permlane16_swap_b32 v81, v82
    v_add_f32 v81, v81, v82
    v_mov_b32 v82, v81
    s_nop 1
    v_permlane32_swap_b32 v81, v82
    v_add_f32 v81, v81, v82
    s_mov_b64 exec, 3
    ds_write2_b32 v4, v80, v81 offset0:0 offset1:4
    s_mov_b64 exec, 1
    ds_add_u32 v6, v7 offset:8
    s_mov_b64 exec, -1

S_k2:
Ls_52:
    ds_read_b32 v5, v6 offset:8
    ds_read_b128 v[96:99], v15
    ds_read_b128 v[100:103], v15 offset:16
    ds_read_b128 v[32:35], v13 offset:0
    ds_read_b128 v[36:39], v13 offset:128
    ds_read_b128 v[40:43], v13 offset:256
    ds_read_b128 v[44:47], v13 offset:384
    ds_read_b128 v[48:51], v13 offset:512
    ds_read_b128 v[52:55], v13 offset:640
    ds_read_b128 v[56:59], v13 offset:768
    ds_read_b128 v[60:63], v13 offset:896
    s_sub_u32 s53, s53, 1
    s_waitcnt lgkmcnt(10)
    v_readfirstlane_b32 s54, v5
    s_cselect_b32 s54, 64, s54
    s_cmp_lt_i32 s54, 4
    s_cbranch_scc1 Ls_52

    s_waitcnt lgkmcnt(8)
    v_max3_f32 v104, v96, v97, v98
    v_max_f32 v104, v104, v99

    v_sub_f32 v96, v96, v104
    v_sub_f32 v97, v97, v104
    v_sub_f32 v98, v98, v104
    v_sub_f32 v99, v99, v104
    v_exp_f32 v96, v96
    v_exp_f32 v97, v97
    v_exp_f32 v98, v98
    v_exp_f32 v99, v99
    s_cmp_lg_u32 s31, 0
    s_cbranch_scc1 L_noml
    v_mul_f32 v106, v96, v100
    v_fmac_f32 v106, v97, v101
    v_fmac_f32 v106, v98, v102
    v_fmac_f32 v106, v99, v103
    v_mov_b32 v105, s30
    v_mov_b32 v107, s30
    s_mov_b64 exec, 0xff

    s_cmp_eq_u32 s34, 1
    s_cbranch_scc0 Lw_54
    buffer_store_dwordx4 v[104:107], v11, s[44:47], s49 offen
    s_branch Le_55
Lw_54:
    buffer_store_dwordx4 v[104:107], v11, s[44:47], s49 offen sc1
Le_55:

    s_mov_b64 exec, -1
L_noml:
    s_waitcnt lgkmcnt(0)

S_v0:
Ls_56:
    ds_read_b32 v5, v6 offset:64
    ds_read_b64_tr_b16 v[16:17], v8 offset:0
    ds_read_b64_tr_b16 v[18:19], v8 offset:4096
    ds_read_b64_tr_b16 v[20:21], v9 offset:0
    ds_read_b64_tr_b16 v[22:23], v9 offset:4096
    s_sub_u32 s53, s53, 1
    s_waitcnt lgkmcnt(4)
    v_readfirstlane_b32 s54, v5
    s_cselect_b32 s54, 64, s54
    s_cmp_lt_i32 s54, 19
    s_cbranch_scc1 Ls_56

    s_waitcnt lgkmcnt(2)
    v_mfma_f32_16x16x32_bf16 v[120:123], v[16:19], v[32:35], 0
    s_waitcnt lgkmcnt(0)
    v_mfma_f32_16x16x32_bf16 v[124:127], v[20:23], v[32:35], 0
S_v1:
Ls_58:
    ds_read_b32 v5, v6 offset:64
    ds_read_b64_tr_b16 v[24:25], v8 offset:8192
    ds_read_b64_tr_b16 v[26:27], v8 offset:12288
    ds_read_b64_tr_b16 v[28:29], v9 offset:8192
    ds_read_b64_tr_b16 v[30:31], v9 offset:12288
    s_sub_u32 s53, s53, 1
    s_waitcnt lgkmcnt(4)
    v_readfirstlane_b32 s54, v5
    s_cselect_b32 s54, 64, s54
    s_cmp_lt_i32 s54, 21
    s_cbranch_scc1 Ls_58

    s_waitcnt lgkmcnt(2)
    v_mfma_f32_16x16x32_bf16 v[120:123], v[24:27], v[36:39], v[120:123]
    s_waitcnt lgkmcnt(0)
    v_mfma_f32_16x16x32_bf16 v[124:127], v[28:31], v[36:39], v[124:127]
S_v2:
Ls_60:
    ds_read_b32 v5, v6 offset:64
    ds_read_b64_tr_b16 v[16:17], v8 offset:16384
    ds_read_b64_tr_b16 v[18:19], v8 offset:20480
    ds_read_b64_tr_b16 v[20:21], v9 offset:16384
    ds_read_b64_tr_b16 v[22:23], v9 offset:20480
    s_sub_u32 s53, s53, 1
    s_waitcnt lgkmcnt(4)
    v_readfirstlane_b32 s54, v5
    s_cselect_b32 s54, 64, s54
    s_cmp_lt_i32 s54, 23
    s_cbranch_scc1 Ls_60

    s_waitcnt lgkmcnt(2)
    v_mfma_f32_16x16x32_bf16 v[128:131], v[16:19], v[40:43], 0
    s_waitcnt lgkmcnt(0)
    v_mfma_f32_16x16x32_bf16 v[132:135], v[20:23], v[40:43], 0
    v_mul_f32 v120, v96, v120
    v_mul_f32 v121, v96, v121
    v_mul_f32 v122, v96, v122
    v_mul_f32 v123, v96, v123
    v_mul_f32 v124, v96, v124
    v_mul_f32 v125, v96, v125
    v_mul_f32 v126, v96, v126
    v_mul_f32 v127, v96, v127
S_v3:
Ls_62:
    ds_read_b32 v5, v6 offset:64
    ds_read_b64_tr_b16 v[24:25], v8 offset:24576
    ds_read_b64_tr_b16 v[26:27], v8 offset:28672
    ds_read_b64_tr_b16 v[28:29], v9 offset:24576
    ds_read_b64_tr_b16 v[30:31], v9 offset:28672
    s_sub_u32 s53, s53, 1
    s_waitcnt lgkmcnt(4)
    v_readfirstlane_b32 s54, v5
    s_cselect_b32 s54, 64, s54
    s_cmp_lt_i32 s54, 25
    s_cbranch_scc1 Ls_62

    s_waitcnt lgkmcnt(2)
    v_mfma_f32_16x16x32_bf16 v[128:131], v[24:27], v[44:47], v[128:131]
    s_waitcnt lgkmcnt(0)
    v_mfma_f32_16x16x32_bf16 v[132:135], v[28:31], v[44:47], v[132:135]
S_v4:
Ls_64:
    ds_read_b32 v5, v6 offset:64
    ds_read_b64_tr_b16 v[16:17], v8 offset:32768
    ds_read_b64_tr_b16 v[18:19], v8 offset:36864
    ds_read_b64_tr_b16 v[20:21], v9 offset:32768
    ds_read_b64_tr_b16 v[22:23], v9 offset:36864
    s_sub_u32 s53, s53, 1
    s_waitcnt lgkmcnt(4)
    v_readfirstlane_b32 s54, v5
    s_cselect_b32 s54, 64, s54
    s_cmp_lt_i32 s54, 27
    s_cbranch_scc1 Ls_64

    s_waitcnt lgkmcnt(2)
    v_mfma_f32_16x16x32_bf16 v[136:139], v[16:19], v[48:51], 0
    s_waitcnt lgkmcnt(0)
    v_mfma_f32_16x16x32_bf16 v[140:143], v[20:23], v[48:51], 0
    v_fmac_f32 v120, v97, v128
    v_fmac_f32 v121, v97, v129
    v_fmac_f32 v122, v97, v130
    v_fmac_f32 v123, v97, v131
    v_fmac_f32 v124, v97, v132
    v_fmac_f32 v125, v97, v133
    v_fmac_f32 v126, v97, v134
    v_fmac_f32 v127, v97, v135
S_v5:
Ls_66:
    ds_read_b32 v5, v6 offset:64
    ds_read_b64_tr_b16 v[24:25], v8 offset:40960
    ds_read_b64_tr_b16 v[26:27], v8 offset:45056
    ds_read_b64_tr_b16 v[28:29], v9 offset:40960
    ds_read_b64_tr_b16 v[30:31], v9 offset:45056
    s_sub_u32 s53, s53, 1
    s_waitcnt lgkmcnt(4)
    v_readfirstlane_b32 s54, v5
    s_cselect_b32 s54, 64, s54
    s_cmp_lt_i32 s54, 29
    s_cbranch_scc1 Ls_66

    s_waitcnt lgkmcnt(2)
    v_mfma_f32_16x16x32_bf16 v[136:139], v[24:27], v[52:55], v[136:139]
    s_waitcnt lgkmcnt(0)
    v_mfma_f32_16x16x32_bf16 v[140:143], v[28:31], v[52:55], v[140:143]
S_v6:
Ls_68:
    ds_read_b32 v5, v6 offset:64
    ds_read_b64_tr_b16 v[16:17], v8 offset:49152
    ds_read_b64_tr_b16 v[18:19], v8 offset:53248
    ds_read_b64_tr_b16 v[20:21], v9 offset:49152
    ds_read_b64_tr_b16 v[22:23], v9 offset:53248
    s_sub_u32 s53, s53, 1
    s_waitcnt lgkmcnt(4)
    v_readfirstlane_b32 s54, v5
    s_cselect_b32 s54, 64, s54
    s_cmp_lt_i32 s54, 31
    s_cbranch_scc1 Ls_68

    s_waitcnt lgkmcnt(2)
    v_mfma_f32_16x16x32_bf16 v[144:147], v[16:19], v[56:59], 0
    s_waitcnt lgkmcnt(0)
    v_mfma_f32_16x16x32_bf16 v[148:151], v[20:23], v[56:59], 0
    v_fmac_f32 v120, v98, v136
    v_fmac_f32 v121, v98, v137
    v_fmac_f32 v122, v98, v138
    v_fmac_f32 v123, v98, v139
    v_fmac_f32 v124, v98, v140
    v_fmac_f32 v125, v98, v141
    v_fmac_f32 v126, v98, v142
    v_fmac_f32 v127, v98, v143
S_v7:
Ls_70:
    ds_read_b32 v5, v6 offset:64
    ds_read_b64_tr_b16 v[24:25], v8 offset:57344
    ds_read_b64_tr_b16 v[26:27], v8 offset:61440
    ds_read_b64_tr_b16 v[28:29], v9 offset:57344
    ds_read_b64_tr_b16 v[30:31], v9 offset:61440
    s_sub_u32 s53, s53, 1
    s_waitcnt lgkmcnt(4)
    v_readfirstlane_b32 s54, v5
    s_cselect_b32 s54, 64, s54
    s_cmp_lt_i32 s54, 33
    s_cbranch_scc1 Ls_70

    s_waitcnt lgkmcnt(2)
    v_mfma_f32_16x16x32_bf16 v[144:147], v[24:27], v[60:63], v[144:147]
    s_waitcnt lgkmcnt(0)
    v_mfma_f32_16x16x32_bf16 v[148:151], v[28:31], v[60:63], v[148:151]
    s_nop 5
    v_fmac_f32 v120, v99, v144
    v_fmac_f32 v121, v99, v145
    v_fmac_f32 v122, v99, v146
    v_fmac_f32 v123, v99, v147
    v_fmac_f32 v124, v99, v148
    v_fmac_f32 v125, v99, v149
    v_fmac_f32 v126, v99, v150
    v_fmac_f32 v127, v99, v151
    v_mov_b32_dpp v120, v124 quad_perm:[0,1,2,3] row_mask:0xf bank_mask:0x2
    v_mov_b32_dpp v121, v125 quad_perm:[0,1,2,3] row_mask:0xf bank_mask:0x2
    v_mov_b32_dpp v122, v126 quad_perm:[0,1,2,3] row_mask:0xf bank_mask:0x2
    v_mov_b32_dpp v123, v127 quad_perm:[0,1,2,3] row_mask:0xf bank_mask:0x2
    v_mov_b32_sdwa v120, s30 dst_sel:BYTE_0 dst_unused:UNUSED_PRESERVE src0_sel:BYTE_0
    v_mov_b32_sdwa v121, s30 dst_sel:BYTE_0 dst_unused:UNUSED_PRESERVE src0_sel:BYTE_0
    v_mov_b32_sdwa v122, s30 dst_sel:BYTE_0 dst_unused:UNUSED_PRESERVE src0_sel:BYTE_0
    v_mov_b32_sdwa v123, s30 dst_sel:BYTE_0 dst_unused:UNUSED_PRESERVE src0_sel:BYTE_0
    s_mov_b32 exec_lo, 0x00330033
    s_mov_b32 exec_hi, 0x00330033

    s_cmp_eq_u32 s34, 1
    s_cbranch_scc0 Lw_72
    buffer_store_dwordx4 v[120:123], v10, s[44:47], s48 offen
    s_branch Le_73
Lw_72:
    buffer_store_dwordx4 v[120:123], v10, s[44:47], s48 offen sc1
Le_73:

    s_mov_b64 exec, -1

    s_cmp_ge_u32 s29, 15
    s_cbranch_scc1 L_kend
    s_cmp_ge_u32 s29, 9
    s_cbranch_scc1 L_kpost
    s_mov_b32 s48, s2
    s_cmp_eq_u32 s31, 0
    s_cbranch_scc1 L_red
    s_branch L_w2

S_p0:
    .p2align 12
W_p0:
    s_branch L_KV
L_kpost:
    s_sub_u32 s48, s29, 9
    s_and_b32 s49, s48, 1
    s_lshr_b32 s48, s48, 1
    s_lshl_b32 s50, s28, 1
    s_add_u32 s49, s49, s50
    s_lshl_b32 s50, s49, 13
    s_lshl_b32 s51, s31, 7
    s_add_u32 s50, s50, s51
    s_add_u32 s50, s50, 327680
    s_lshl_b32 s51, s28, 11
    s_bfe_u32 s52, s49, 0x10000
    s_lshl4_add_u32 s51, s52, s51
    s_add_u32 s51, s51, 589824
    v_and_or_b32 v4, v1, 12, v2
    v_and_b32 v14, 3, v1
    v_lshlrev_b32 v3, 4, v14
    v_lshl_add_u32 v3, v4, 9, v3
    v_lshlrev_b32 v4, 7, v4
    s_sub_u32 s58, s31, 1
    s_mul_i32 s52, s48, 3
    s_add_u32 s52, s52, s58
    s_mul_i32 s52, s52, 61440
    s_mul_i32 s49, s49, 384
    s_add_u32 s52, s52, s49
    s_add_u32 s52, s52, 4194304
    s_lshl_b32 s55, s58, 14
    s_and_b32 s55, s55, 0xffff

    v_lshrrev_b32 v9, 2, v0
    v_lshlrev_b32 v8, 7, v9
    v_bfe_u32 v9, v0, 3, 2
    v_lshl_add_u32 v8, v9, 5, v8
    v_and_b32 v9, 3, v0
    v_lshl_add_u32 v8, v9, 3, v8

    v_add_u32 v8, s55, v8
    v_xor_b32 v9, 32, v8
    v_xor_b32 v10, 64, v8
    v_xor_b32 v11, 96, v8
    v_and_b32 v13, 3, v1
    v_mul_u32_u24 v13, 18, v13
    v_lshrrev_b32 v12, 3, v1
    v_add_u32 v13, v13, v12
    v_mul_u32_u24 v13, 30720, v13
    v_lshl_add_u32 v12, v2, 4, v13
    v_and_b32 v13, 4, v1
    v_lshl_add_u32 v12, v13, 4, v12

    v_and_b32 v13, 3, v1
    v_lshlrev_b32 v13, 4, v13
    v_lshl_add_u32 v13, v2, 6, v13
    v_add_u32 v13, 156160, v13
    s_lshl_b32 s55, s31, 8
    s_add_u32 s55, s55, 156160
    v_lshl_add_u32 v14, v14, 6, s55
    v_lshl_add_u32 v14, v2, 4, v14
    s_lshl_b32 s49, s31, 2
    s_add_u32 s49, s49, 33
    s_cmp_eq_u32 s31, 0
    s_cselect_b32 s56, 1, 0
    s_mov_b64 s[76:77], -1
    s_mov_b32 s55, 32768

Ls_74:
    ds_read_b32 v5, v6 offset:64
    s_sub_u32 s53, s53, 1
    s_waitcnt lgkmcnt(0)
    v_readfirstlane_b32 s54, v5
    s_cselect_b32 s54, 64, s54
    s_cmp_lt_i32 s54, 41
    s_cbranch_scc1 Ls_74

    buffer_load_dwordx4 v[80:83], v3, s[44:47], s50 offen
    buffer_load_dwordx4 v[84:87], v3, s[44:47], s50 offen offset:64
    buffer_load_dwordx4 v[88:91], v4, s[44:47], s51 offen
    s_branch L_pl1

L_pl:
    buffer_load_dwordx4 v[80:83], v3, s[44:47], s50 offen sc1
    buffer_load_dwordx4 v[84:87], v3, s[44:47], s50 offen offset:64 sc1
    buffer_load_dwordx4 v[88:91], v4, s[44:47], s51 offen sc1
    s_mov_b64 exec, -1
L_pl1:
    s_cmp_lg_u32 s56, 0
    s_cbranch_scc1 L_pl2

    s_sub_u32 s57, s49, 1
Ls_76:
    ds_read_b32 v92, v6 offset:64
    s_sub_u32 s53, s53, 1
    s_waitcnt lgkmcnt(0)
    v_readfirstlane_b32 s54, v92
    s_cselect_b32 s54, 64, s54
    s_cmp_lt_i32 s54, s57
    s_cbranch_scc1 Ls_76

    ds_read_b64_tr_b16 v[16:17], v8 offset:0
    ds_read_b64_tr_b16 v[18:19], v8 offset:2048
    ds_read_b64_tr_b16 v[20:21], v9 offset:0
    ds_read_b64_tr_b16 v[22:23], v9 offset:2048
    ds_read_b64_tr_b16 v[24:25], v10 offset:0
    ds_read_b64_tr_b16 v[26:27], v10 offset:2048
    ds_read_b64_tr_b16 v[28:29], v11 offset:0
    ds_read_b64_tr_b16 v[30:31], v11 offset:2048
    ds_read_b64_tr_b16 v[32:33], v8 offset:4096
    ds_read_b64_tr_b16 v[34:35], v8 offset:6144
    ds_read_b64_tr_b16 v[36:37], v9 offset:4096
    ds_read_b64_tr_b16 v[38:39], v9 offset:6144
    ds_read_b64_tr_b16 v[40:41], v10 offset:4096
    ds_read_b64_tr_b16 v[42:43], v10 offset:6144
    ds_read_b64_tr_b16 v[44:45], v11 offset:4096
    ds_read_b64_tr_b16 v[46:47], v11 offset:6144
    ds_read_b64_tr_b16 v[48:49], v8 offset:8192
    ds_read_b64_tr_b16 v[50:51], v8 offset:10240
    ds_read_b64_tr_b16 v[52:53], v9 offset:8192
    ds_read_b64_tr_b16 v[54:55], v9 offset:10240
    ds_read_b64_tr_b16 v[56:57], v10 offset:8192
    ds_read_b64_tr_b16 v[58:59], v10 offset:10240
    ds_read_b64_tr_b16 v[60:61], v11 offset:8192
    ds_read_b64_tr_b16 v[62:63], v11 offset:10240
    s_mov_b32 s56, 1
L_pl2:
    s_waitcnt vmcnt(0)
    v_bitop3_b32 v92, v80, v81, s30 bitop3:0x7e
    v_bitop3_b32 v93, v82, v83, s30 bitop3:0x7e
    v_bitop3_b32 v94, v84, v85, s30 bitop3:0x7e
    v_bitop3_b32 v95, v86, v87, s30 bitop3:0x7e
    v_bitop3_b32 v96, v89, v91, s30 bitop3:0x7e
    v_or3_b32 v92, v92, v93, v94
    v_or_b32 v92, v92, v95
    v_and_b32 v92, 0xff, v92
    v_or_b32 v92, v92, v96

    v_cmp_ne_u32 vcc, 0, v92
    s_cbranch_vccz L_pl3
    s_sub_u32 s55, s55, 1
    s_cbranch_scc1 L_pl3
    v_or_b32_dpp v92, v92, v92 quad_perm:[1,0,3,2] row_mask:0xf bank_mask:0xf
    s_nop 1
    v_or_b32_dpp v92, v92, v92 quad_perm:[2,3,0,1] row_mask:0xf bank_mask:0xf
    v_cmp_ne_u32 vcc, 0, v92
    s_mov_b64 exec, vcc
    s_branch L_pl

L_pl3:
    s_mov_b64 exec, -1

    v_max_f32_dpp v92, v88, v88 row_ror:4 row_mask:0xf bank_mask:0xf
    s_nop 1
    v_max_f32_dpp v92, v92, v92 row_ror:8 row_mask:0xf bank_mask:0xf
    v_sub_f32 v92, v88, v92
    v_exp_f32 v92, v92
    s_nop 0
    v_mul_f32 v93, v92, v90
    s_nop 1
    v_add_f32_dpp v93, v93, v93 row_ror:4 row_mask:0xf bank_mask:0xf
    s_nop 1
    v_add_f32_dpp v93, v93, v93 row_ror:8 row_mask:0xf bank_mask:0xf
    v_rcp_f32 v93, v93
    s_nop 0
    v_mul_f32 v92, v92, v93

    v_mul_f32 v100, v92, v80
    v_mul_f32 v101, v92, v81
    v_mul_f32 v102, v92, v82
    v_mul_f32 v103, v92, v83
    v_mul_f32 v104, v92, v84
    v_mul_f32 v105, v92, v85
    v_mul_f32 v106, v92, v86
    v_mul_f32 v107, v92, v87
    v_add_f32_dpp v100, v100, v100 row_ror:4 row_mask:0xf bank_mask:0xf
    v_add_f32_dpp v101, v101, v101 row_ror:4 row_mask:0xf bank_mask:0xf
    v_add_f32_dpp v102, v102, v102 row_ror:4 row_mask:0xf bank_mask:0xf
    v_add_f32_dpp v103, v103, v103 row_ror:4 row_mask:0xf bank_mask:0xf
    v_add_f32_dpp v104, v104, v104 row_ror:4 row_mask:0xf bank_mask:0xf
    v_add_f32_dpp v105, v105, v105 row_ror:4 row_mask:0xf bank_mask:0xf
    v_add_f32_dpp v106, v106, v106 row_ror:4 row_mask:0xf bank_mask:0xf
    v_add_f32_dpp v107, v107, v107 row_ror:4 row_mask:0xf bank_mask:0xf
    v_add_f32_dpp v100, v100, v100 row_ror:8 row_mask:0xf bank_mask:0xf
    v_add_f32_dpp v101, v101, v101 row_ror:8 row_mask:0xf bank_mask:0xf
    v_add_f32_dpp v102, v102, v102 row_ror:8 row_mask:0xf bank_mask:0xf
    v_add_f32_dpp v103, v103, v103 row_ror:8 row_mask:0xf bank_mask:0xf
    v_add_f32_dpp v104, v104, v104 row_ror:8 row_mask:0xf bank_mask:0xf
    v_add_f32_dpp v105, v105, v105 row_ror:8 row_mask:0xf bank_mask:0xf
    v_add_f32_dpp v106, v106, v106 row_ror:8 row_mask:0xf bank_mask:0xf
    v_add_f32_dpp v107, v107, v107 row_ror:8 row_mask:0xf bank_mask:0xf
    v_cvt_pk_bf16_f32 v100, v100, v101
    v_cvt_pk_bf16_f32 v101, v102, v103
    v_cvt_pk_bf16_f32 v102, v104, v105
    v_cvt_pk_bf16_f32 v103, v106, v107
    s_mov_b32 exec_lo, 0x000f000f
    s_mov_b32 exec_hi, 0x000f000f
    ds_write_b128 v14, v[100:103]
    s_mov_b64 exec, 1
    ds_add_u32 v6, v7 offset:12
    s_mov_b64 exec, -1
    s_cmp_eq_u32 s31, 0
    s_cbranch_scc1 L_kend

L_ps:
    ds_read2_b32 v[92:93], v6 offset0:3 offset1:16

    ds_read_b128 v[112:115], v13 offset:0
    ds_read_b128 v[116:119], v13 offset:256
    ds_read_b128 v[120:123], v13 offset:512
    ds_read_b128 v[124:127], v13 offset:768
    ds_read_b64_tr_b16 v[64:65], v8 offset:12288
    ds_read_b64_tr_b16 v[66:67], v8 offset:14336
    ds_read_b64_tr_b16 v[68:69], v9 offset:12288
    ds_read_b64_tr_b16 v[70:71], v9 offset:14336
    ds_read_b64_tr_b16 v[72:73], v10 offset:12288
    ds_read_b64_tr_b16 v[74:75], v10 offset:14336
    ds_read_b64_tr_b16 v[76:77], v11 offset:12288
    ds_read_b64_tr_b16 v[78:79], v11 offset:14336
    s_waitcnt lgkmcnt(12)
    v_readfirstlane_b32 s54, v92
    v_readfirstlane_b32 s57, v93
    s_cmp_lt_i32 s54, 4
    s_cselect_b32 s57, 0, s57
    s_sub_u32 s53, s53, 1
    s_cselect_b32 s57, 64, s57
    s_cmp_lt_i32 s57, s49
    s_cbranch_scc1 L_ps

    s_waitcnt lgkmcnt(11)
    v_mfma_f32_16x16x32_bf16 v[96:99], v[16:19], v[112:115], 0
    v_mfma_f32_16x16x32_bf16 v[100:103], v[20:23], v[112:115], 0
    v_mfma_f32_16x16x32_bf16 v[104:107], v[24:27], v[112:115], 0
    v_mfma_f32_16x16x32_bf16 v[108:111], v[28:31], v[112:115], 0
    s_waitcnt lgkmcnt(10)
    v_mfma_f32_16x16x32_bf16 v[96:99], v[32:35], v[116:119], v[96:99]
    v_mfma_f32_16x16x32_bf16 v[100:103], v[36:39], v[116:119], v[100:103]
    v_mfma_f32_16x16x32_bf16 v[104:107], v[40:43], v[116:119], v[104:107]
    v_mfma_f32_16x16x32_bf16 v[108:111], v[44:47], v[116:119], v[108:111]
    s_waitcnt lgkmcnt(9)
    v_mfma_f32_16x16x32_bf16 v[96:99], v[48:51], v[120:123], v[96:99]
    v_mfma_f32_16x16x32_bf16 v[100:103], v[52:55], v[120:123], v[100:103]
    v_mfma_f32_16x16x32_bf16 v[104:107], v[56:59], v[120:123], v[104:107]
    v_mfma_f32_16x16x32_bf16 v[108:111], v[60:63], v[120:123], v[108:111]
    s_waitcnt lgkmcnt(0)
    v_mfma_f32_16x16x32_bf16 v[96:99], v[64:67], v[124:127], v[96:99]
    v_mfma_f32_16x16x32_bf16 v[100:103], v[68:71], v[124:127], v[100:103]
    v_mfma_f32_16x16x32_bf16 v[104:107], v[72:75], v[124:127], v[104:107]
    v_mfma_f32_16x16x32_bf16 v[108:111], v[76:79], v[124:127], v[108:111]
    s_nop 5
    v_mov_b32_dpp v96, v100 quad_perm:[0,1,2,3] row_mask:0xf bank_mask:0x2
    v_mov_b32_dpp v97, v101 quad_perm:[0,1,2,3] row_mask:0xf bank_mask:0x2
    v_mov_b32_dpp v98, v102 quad_perm:[0,1,2,3] row_mask:0xf bank_mask:0x2
    v_mov_b32_dpp v99, v103 quad_perm:[0,1,2,3] row_mask:0xf bank_mask:0x2
    v_mov_b32_dpp v96, v104 quad_perm:[0,1,2,3] row_mask:0xf bank_mask:0x4
    v_mov_b32_dpp v97, v105 quad_perm:[0,1,2,3] row_mask:0xf bank_mask:0x4
    v_mov_b32_dpp v98, v106 quad_perm:[0,1,2,3] row_mask:0xf bank_mask:0x4
    v_mov_b32_dpp v99, v107 quad_perm:[0,1,2,3] row_mask:0xf bank_mask:0x4
    v_mov_b32_dpp v96, v108 quad_perm:[0,1,2,3] row_mask:0xf bank_mask:0x8
    v_mov_b32_dpp v97, v109 quad_perm:[0,1,2,3] row_mask:0xf bank_mask:0x8
    v_mov_b32_dpp v98, v110 quad_perm:[0,1,2,3] row_mask:0xf bank_mask:0x8
    v_mov_b32_dpp v99, v111 quad_perm:[0,1,2,3] row_mask:0xf bank_mask:0x8
    v_mov_b32_sdwa v96, s30 dst_sel:BYTE_0 dst_unused:UNUSED_PRESERVE src0_sel:BYTE_0
    v_mov_b32_sdwa v97, s30 dst_sel:BYTE_0 dst_unused:UNUSED_PRESERVE src0_sel:BYTE_0
    v_mov_b32_sdwa v98, s30 dst_sel:BYTE_0 dst_unused:UNUSED_PRESERVE src0_sel:BYTE_0
    v_mov_b32_sdwa v99, s30 dst_sel:BYTE_0 dst_unused:UNUSED_PRESERVE src0_sel:BYTE_0
    buffer_store_dwordx4 v[96:99], v12, s[44:47], s52 offen sc1

L_kend:
    s_mov_b64 exec, -1
L_end:
    s_endpgm
.section .rodata,"a"
.p2align 6
.amdhsa_kernel gated_mix__sliding_block_cached__dense_activation_relu__decode_kernel
  .amdhsa_next_free_vgpr 208
  .amdhsa_next_free_sgpr 102
  .amdhsa_accum_offset 208
  .amdhsa_group_segment_fixed_size 0
  .amdhsa_kernarg_size 96
  .amdhsa_user_sgpr_count 2
  .amdhsa_user_sgpr_kernarg_segment_ptr 1
  .amdhsa_system_sgpr_workgroup_id_x 1
.end_amdhsa_kernel
```
